```python
import torch

def _softmax(x, axis=-1):
    return torch.softmax(x, dim=axis)
def _gelu(x):
    return torch.nn.functional.gelu(x, approximate="tanh")
def _silu(x):
    return torch.nn.functional.silu(x)
def _sigmoid(x):
    return torch.sigmoid(x)
def _layernorm(x, axis=-1, eps=1e-5):
    m = x.mean(dim=axis, keepdim=True)
    v = x.var(dim=axis, keepdim=True, unbiased=False)
    return (x - m) / torch.sqrt(v + eps)
def _scatter_add(tgt, idx, src, axis=0):
    return tgt.clone().index_add_(axis, idx, src)
def _segment_sum(src, seg, n):
    out = torch.zeros((n,) + src.shape[1:], dtype=src.dtype)
    return out.index_add_(0, seg, src)
def _pad(x, pw):
    flat = tuple(v for pair in reversed(pw) for v in pair)
    return torch.nn.functional.pad(x, flat)

kernel_name = 'sequential_preLN__mha_block_cached__dense_activation_gelu__decode'

def setup_inputs():

    _w = (lambda a: (lambda t: t.to(torch.bfloat16) if t.is_floating_point() else t)(torch.as_tensor(a)))
    def _A_setup():
        B, Sq, D = 4, 1, 640
        H, Sk, Dh = 32, 8192, 192
        return {
            "x": _w((lambda *s: torch.randn(*s, dtype=torch.bfloat16) * 0.1)(B, Sq, D)),
            "k_cache": _w((lambda *s: torch.randn(*s, dtype=torch.bfloat16) * 1.6)(B, H, Sk, Dh)),
            "v_cache": _w((lambda *s: torch.randn(*s, dtype=torch.bfloat16) * 1.6)(B, H, Sk, Dh)),
            "wq": _w((lambda *s: torch.randn(*s, dtype=torch.bfloat16) * 1.6)(D, H * Dh) * (D ** -0.5)),
            "wo": _w((lambda *s: torch.randn(*s, dtype=torch.bfloat16) * 1.6)(H * Dh, D) * ((H * Dh) ** -0.5)),
        }
    _A_in = _A_setup()

    def _B_setup():
        B, S, D, F = 4, 1, 640, 1536
        return {
            "x": _w((lambda *s: torch.randn(*s, dtype=torch.bfloat16) * 0.1)(B, S, D)),
            "w1": _w((lambda *s: torch.randn(*s, dtype=torch.bfloat16) * 3.2)(D, F) * (D ** -0.5)),
            "b1": _w((lambda *s: torch.randn(*s, dtype=torch.bfloat16) * 3.2)(F) * 0.01),
            "w2": _w((lambda *s: torch.randn(*s, dtype=torch.bfloat16) * 3.2)(F, D) * (F ** -0.5)),
            "b2": _w((lambda *s: torch.randn(*s, dtype=torch.bfloat16) * 3.2)(D) * 0.01),
        }
    _B_in = _B_setup()

    return {
        "A_x": _A_in["x"],
        "A_k_cache": _A_in["k_cache"],
        "A_v_cache": _A_in["v_cache"],
        "A_wq": _A_in["wq"],
        "A_wo": _A_in["wo"],
        "B_x": _B_in["x"],
        "B_w1": _B_in["w1"],
        "B_b1": _B_in["b1"],
        "B_w2": _B_in["w2"],
        "B_b2": _B_in["b2"],
    }

def reference(A_x, A_k_cache, A_v_cache, A_wq, A_wo, B_x, B_w1, B_b1, B_w2, B_b2):
    def _A_ref(x, k_cache, v_cache, wq, wo):
        B, Sq, D = x.shape
        H, Dh = 32, 192
        q = (lambda x, *d: x.permute(*d))((x @ wq).reshape(B, Sq, H, Dh), 0, 2, 1, 3)
        scores = torch.einsum("bhqd,bhkd->bhqk", q, k_cache) * (Dh ** -0.5)
        p = _softmax(scores, axis=-1)
        o = torch.einsum("bhqk,bhkd->bhqd", p, v_cache)
        return (lambda x, *d: x.permute(*d))(o, 0, 2, 1, 3).reshape(B, Sq, H * Dh) @ wo

    def _B_ref(x, w1, b1, w2, b2):
        h = torch.einsum("bsd,df->bsf", x, w1) + b1
        h = _gelu(h)
        return torch.einsum("bsf,fd->bsd", h, w2) + b2

    x = A_x
    h = x + _A_ref(_layernorm(x, axis=-1), A_k_cache, A_v_cache, A_wq, A_wo)
    h2 = h + _B_ref(_layernorm(h, axis=-1), B_w1, B_b1, B_w2, B_b2)
    return h2
```

```asm
; @launch grid=(256,1,1) block=(512,1,1) lds=54272
.amdgcn_target "amdgcn-amd-amdhsa--gfx950"
.text
.globl sequential_preLN__mha_block_cached__dense_activation_gelu__decode_kernel
.p2align 8
.type sequential_preLN__mha_block_cached__dense_activation_gelu__decode_kernel,@function
sequential_preLN__mha_block_cached__dense_activation_gelu__decode_kernel:
    s_cmp_ge_u32 s2, 256
    s_cbranch_scc1 L_end
    s_load_dwordx16 s[56:71], s[0:1], 0
    s_load_dwordx8 s[72:79], s[0:1], 64
    s_load_dwordx2 s[80:81], s[0:1], 96
    v_lshrrev_b32 v1, 6, v0
    v_and_b32 v0, 63, v0
    v_readfirstlane_b32 s3, v1
    s_and_b32 s4, s2, 7
    s_lshl_b32 s4, s4, 5
    s_lshr_b32 s2, s2, 3
    s_add_u32 s2, s2, s4
    s_lshr_b32 s4, s2, 3
    s_and_b32 s5, s2, 7
    s_cmp_ge_u32 s3, 4
    s_cbranch_scc1 L_helper
    s_setprio 2
    v_lshrrev_b32 v2, 3, v0
    v_mul_u32_u24 v1, 384, v2
    v_and_b32 v3, 7, v0
    v_lshlrev_b32 v34, 4, v3
    v_add_u32 v1, v1, v34
    s_and_b32 s7, s4, 3
    s_lshr_b32 s6, s4, 2
    s_lshl3_add_u32 s7, s7, s6
    s_mul_i32 s82, s7, 3145728
    s_lshl2_add_u32 s6, s5, s3
    s_mul_i32 s6, s6, 6144
    s_add_u32 s82, s82, s6
    s_mov_b32 s85, s82
    s_mov_b32 s88, 393216
    s_waitcnt lgkmcnt(0)
    s_mov_b32 s8, s58
    s_and_b32 s9, s59, 0xffff
    s_mov_b32 s10, 402653184
    s_mov_b32 s11, 0x20000
    buffer_load_dwordx4 v[64:67], v1, s[8:11], s82 offen offset:0 nt
    buffer_load_dwordx4 v[68:71], v1, s[8:11], s82 offen offset:128 nt
    buffer_load_dwordx4 v[72:75], v1, s[8:11], s82 offen offset:256 nt
    buffer_load_dwordx4 v[76:79], v1, s[8:11], s82 offen offset:3072 nt
    buffer_load_dwordx4 v[80:83], v1, s[8:11], s82 offen offset:3200 nt
    buffer_load_dwordx4 v[84:87], v1, s[8:11], s82 offen offset:3328 nt
    s_load_dword s57, s[80:81], 0
    s_mov_b32 s12, s60
    s_and_b32 s13, s61, 0xffff
    s_mov_b32 s14, 402653184
    s_mov_b32 s15, 0x20000
    s_mov_b32 s16, s80
    s_and_b32 s17, s81, 0xffff
    s_mov_b32 s18, 1956864
    s_mov_b32 s19, 0x20000
    s_add_u32 s83, s85, 196608
    s_waitcnt vmcnt(0)
    buffer_load_dwordx4 v[88:91], v1, s[8:11], s83 offen offset:0 nt
    buffer_load_dwordx4 v[92:95], v1, s[8:11], s83 offen offset:128 nt
    buffer_load_dwordx4 v[96:99], v1, s[8:11], s83 offen offset:256 nt
    buffer_load_dwordx4 v[100:103], v1, s[8:11], s83 offen offset:3072 nt
    buffer_load_dwordx4 v[104:107], v1, s[8:11], s83 offen offset:3200 nt
    buffer_load_dwordx4 v[108:111], v1, s[8:11], s83 offen offset:3328 nt
    s_add_u32 s83, s85, 393216
    s_waitcnt vmcnt(0)
    buffer_load_dwordx4 v[112:115], v1, s[8:11], s83 offen offset:0 nt
    buffer_load_dwordx4 v[116:119], v1, s[8:11], s83 offen offset:128 nt
    buffer_load_dwordx4 v[120:123], v1, s[8:11], s83 offen offset:256 nt
    buffer_load_dwordx4 v[124:127], v1, s[8:11], s83 offen offset:3072 nt
    buffer_load_dwordx4 v[128:131], v1, s[8:11], s83 offen offset:3200 nt
    buffer_load_dwordx4 v[132:135], v1, s[8:11], s83 offen offset:3328 nt
    s_barrier
    s_mov_b32 s89, 2
    s_and_b32 s6, s4, 1
    s_sub_u32 s6, s6, s5
    s_mul_i32 s6, s6, 49152
    s_add_u32 s90, s85, s6
    s_add_u32 s90, s90, 304939008
    s_add_u32 s91, s90, 98304
    s_mul_i32 s6, s3, 2112
    s_add_u32 s6, s6, 2048
    v_lshlrev_b32 v2, 2, v2
    v_add_u32 v2, s6, v2
    v_min_u32 v28, 23, v0
    v_lshl_add_u32 v28, v28, 2, s6
    v_mov_b32 v29, 0xff80ff80
    ds_write_b32 v28, v29 offset:2016
    v_add_u32 v34, 256, v34
    v_and_b32 v28, 1, v0
    v_cmp_eq_u32 vcc, 0, v28
    v_mov_b32 v29, 0xffff0000
    v_mov_b32 v30, 0xffff
    v_cndmask_b32 v28, v29, v30, vcc
    v_lshrrev_b32 v29, 1, v3
    v_cmp_eq_u32 vcc, 0, v29
    s_nop 1
    v_cndmask_b32 v4, 0, v28, vcc
    v_cmp_eq_u32 vcc, 1, v29
    s_nop 1
    v_cndmask_b32 v5, 0, v28, vcc
    v_cmp_eq_u32 vcc, 2, v29
    s_nop 1
    v_cndmask_b32 v6, 0, v28, vcc
    v_cmp_eq_u32 vcc, 3, v29
    s_nop 1
    v_cndmask_b32 v7, 0, v28, vcc
    v_lshlrev_b32 v3, 4, v3
    v_bfe_u32 v28, v0, 4, 1
    v_lshlrev_b32 v28, 7, v28
    v_add_u32 v3, v3, v28
    v_lshrrev_b32 v28, 5, v0
    v_mul_u32_u24 v28, 768, v28
    v_add_u32 v3, v3, v28
    s_mul_i32 s6, s3, 1536
    s_add_u32 s6, s6, 10496
    v_add_u32 v3, s6, v3
    v_mov_b32 v33, 1
    v_mov_b32 v32, 16
    v_mov_b32 v35, 0
    v_mov_b32 v31, 0
    s_add_u32 s83, s85, 589824
    s_waitcnt vmcnt(0)
    buffer_load_dwordx4 v[136:139], v1, s[8:11], s83 offen offset:0 nt
    buffer_load_dwordx4 v[140:143], v1, s[8:11], s83 offen offset:128 nt
    buffer_load_dwordx4 v[144:147], v1, s[8:11], s83 offen offset:256 nt
    buffer_load_dwordx4 v[148:151], v1, s[8:11], s83 offen offset:3072 nt
    buffer_load_dwordx4 v[152:155], v1, s[8:11], s83 offen offset:3200 nt
    buffer_load_dwordx4 v[156:159], v1, s[8:11], s83 offen offset:3328 nt
    s_add_u32 s83, s85, 786432
    s_waitcnt vmcnt(0)
    buffer_load_dwordx4 v[160:163], v1, s[8:11], s83 offen offset:0 nt
    buffer_load_dwordx4 v[164:167], v1, s[8:11], s83 offen offset:128 nt
    buffer_load_dwordx4 v[168:171], v1, s[8:11], s83 offen offset:256 nt
    buffer_load_dwordx4 v[172:175], v1, s[8:11], s83 offen offset:3072 nt
    buffer_load_dwordx4 v[176:179], v1, s[8:11], s83 offen offset:3200 nt
    buffer_load_dwordx4 v[180:183], v1, s[8:11], s83 offen offset:3328 nt
    s_add_u32 s83, s85, 983040
    s_waitcnt vmcnt(0)
    buffer_load_dwordx4 v[184:187], v1, s[8:11], s83 offen offset:0 nt
    buffer_load_dwordx4 v[188:191], v1, s[8:11], s83 offen offset:128 nt
    buffer_load_dwordx4 v[192:195], v1, s[8:11], s83 offen offset:256 nt
    buffer_load_dwordx4 v[196:199], v1, s[8:11], s83 offen offset:3072 nt
    buffer_load_dwordx4 v[200:203], v1, s[8:11], s83 offen offset:3200 nt
    buffer_load_dwordx4 v[204:207], v1, s[8:11], s83 offen offset:3328 nt
    s_add_u32 s83, s85, 1179648
    s_waitcnt vmcnt(0)
    buffer_load_dwordx4 v[208:211], v1, s[8:11], s83 offen offset:0 nt
    buffer_load_dwordx4 v[212:215], v1, s[8:11], s83 offen offset:128 nt
    buffer_load_dwordx4 v[216:219], v1, s[8:11], s83 offen offset:256 nt
    buffer_load_dwordx4 v[220:223], v1, s[8:11], s83 offen offset:3072 nt
    buffer_load_dwordx4 v[224:227], v1, s[8:11], s83 offen offset:3200 nt
    buffer_load_dwordx4 v[228:231], v1, s[8:11], s83 offen offset:3328 nt
    s_add_u32 s83, s85, 1376256
    s_waitcnt vmcnt(0)
    buffer_load_dwordx4 v[232:235], v1, s[8:11], s83 offen offset:0 nt
    buffer_load_dwordx4 v[236:239], v1, s[8:11], s83 offen offset:128 nt
    buffer_load_dwordx4 v[240:243], v1, s[8:11], s83 offen offset:256 nt
    buffer_load_dwordx4 v[244:247], v1, s[8:11], s83 offen offset:3072 nt
    buffer_load_dwordx4 v[248:251], v1, s[8:11], s83 offen offset:3200 nt
    buffer_load_dwordx4 v[252:255], v1, s[8:11], s83 offen offset:3328 nt
    s_add_u32 s83, s85, 1572864
    s_waitcnt vmcnt(0)
    buffer_load_dwordx4 v[40:43], v1, s[8:11], s83 offen offset:0 nt
    buffer_load_dwordx4 v[44:47], v1, s[8:11], s83 offen offset:128 nt
    buffer_load_dwordx4 v[48:51], v1, s[8:11], s83 offen offset:256 nt
    buffer_load_dwordx4 v[52:55], v1, s[8:11], s83 offen offset:3072 nt
    buffer_load_dwordx4 v[56:59], v1, s[8:11], s83 offen offset:3200 nt
    buffer_load_dwordx4 v[60:63], v1, s[8:11], s83 offen offset:3328 nt
    s_mov_b32 s94, 0x40000
L_qrdy_1:
    ds_read_b32 v28, v35 offset:132
    s_waitcnt lgkmcnt(0)
    v_readfirstlane_b32 s93, v28
    s_cmp_ge_u32 s93, 4
    s_cbranch_scc1 L_qrdy_ok_2
    s_sleep 1
    s_sub_u32 s94, s94, 1
    s_cmp_lg_u32 s94, 0
    s_cbranch_scc1 L_qrdy_1
L_qrdy_ok_2:
    ds_read_b128 v[8:11], v34 offset:0
    ds_read_b128 v[12:15], v34 offset:128
    ds_read_b128 v[16:19], v34 offset:256
    v_add_u32 v34, 384, v34
    s_waitcnt lgkmcnt(0)
    v_dot2_f32_bf16 v28, v64, v8, 0
    v_dot2_f32_bf16 v29, v70, v14, 0
    v_dot2_f32_bf16 v30, v76, v8, 0
    v_dot2_f32_bf16 v31, v82, v14, 0
    v_dot2_f32_bf16 v28, v65, v9, v28
    v_dot2_f32_bf16 v29, v71, v15, v29
    v_dot2_f32_bf16 v30, v77, v9, v30
    v_dot2_f32_bf16 v31, v83, v15, v31
    v_dot2_f32_bf16 v28, v66, v10, v28
    v_dot2_f32_bf16 v29, v72, v16, v29
    v_dot2_f32_bf16 v30, v78, v10, v30
    v_dot2_f32_bf16 v31, v84, v16, v31
    v_dot2_f32_bf16 v28, v67, v11, v28
    v_dot2_f32_bf16 v29, v73, v17, v29
    v_dot2_f32_bf16 v30, v79, v11, v30
    v_dot2_f32_bf16 v31, v85, v17, v31
    v_dot2_f32_bf16 v28, v68, v12, v28
    v_dot2_f32_bf16 v29, v74, v18, v29
    v_dot2_f32_bf16 v30, v80, v12, v30
    v_dot2_f32_bf16 v31, v86, v18, v31
    v_dot2_f32_bf16 v28, v69, v13, v28
    v_dot2_f32_bf16 v29, v75, v19, v29
    v_dot2_f32_bf16 v30, v81, v13, v30
    v_dot2_f32_bf16 v31, v87, v19, v31
    s_nop 0
    v_add_f32 v28, v28, v29
    s_nop 0
    v_add_f32 v30, v30, v31
    v_add_f32_dpp v28, v28, v28 quad_perm:[1,0,3,2] row_mask:0xf bank_mask:0xf
    s_nop 0
    v_add_f32_dpp v30, v30, v30 quad_perm:[1,0,3,2] row_mask:0xf bank_mask:0xf
    v_add_f32_dpp v28, v28, v28 quad_perm:[2,3,0,1] row_mask:0xf bank_mask:0xf
    s_nop 0
    v_add_f32_dpp v30, v30, v30 quad_perm:[2,3,0,1] row_mask:0xf bank_mask:0xf
    v_add_f32_dpp v28, v28, v28 row_half_mirror row_mask:0xf bank_mask:0xf
    s_nop 0
    v_add_f32_dpp v30, v30, v30 row_half_mirror row_mask:0xf bank_mask:0xf
    v_cvt_pk_bf16_f32 v28, v28, v30
    v_lshlrev_b32 v29, 16, v28
    v_and_b32 v30, 0xffff0000, v28
    v_mul_f32 v29, 0x3d93cd3a, v29
    v_mul_f32 v30, 0x3d93cd3a, v30
    v_cvt_pk_bf16_f32 v28, v29, v30
    ds_write_b32 v2, v28 offset:0
    s_add_u32 s83, s85, 1769472
    s_waitcnt vmcnt(0)
    buffer_load_dwordx4 v[64:67], v1, s[8:11], s83 offen offset:0 nt
    buffer_load_dwordx4 v[68:71], v1, s[8:11], s83 offen offset:128 nt
    buffer_load_dwordx4 v[72:75], v1, s[8:11], s83 offen offset:256 nt
    buffer_load_dwordx4 v[76:79], v1, s[8:11], s83 offen offset:3072 nt
    buffer_load_dwordx4 v[80:83], v1, s[8:11], s83 offen offset:3200 nt
    buffer_load_dwordx4 v[84:87], v1, s[8:11], s83 offen offset:3328 nt
    v_dot2_f32_bf16 v28, v88, v8, 0
    v_dot2_f32_bf16 v29, v94, v14, 0
    v_dot2_f32_bf16 v30, v100, v8, 0
    v_dot2_f32_bf16 v31, v106, v14, 0
    v_dot2_f32_bf16 v28, v89, v9, v28
    v_dot2_f32_bf16 v29, v95, v15, v29
    v_dot2_f32_bf16 v30, v101, v9, v30
    v_dot2_f32_bf16 v31, v107, v15, v31
    v_dot2_f32_bf16 v28, v90, v10, v28
    v_dot2_f32_bf16 v29, v96, v16, v29
    v_dot2_f32_bf16 v30, v102, v10, v30
    v_dot2_f32_bf16 v31, v108, v16, v31
    v_dot2_f32_bf16 v28, v91, v11, v28
    v_dot2_f32_bf16 v29, v97, v17, v29
    v_dot2_f32_bf16 v30, v103, v11, v30
    v_dot2_f32_bf16 v31, v109, v17, v31
    v_dot2_f32_bf16 v28, v92, v12, v28
    v_dot2_f32_bf16 v29, v98, v18, v29
    v_dot2_f32_bf16 v30, v104, v12, v30
    v_dot2_f32_bf16 v31, v110, v18, v31
    v_dot2_f32_bf16 v28, v93, v13, v28
    v_dot2_f32_bf16 v29, v99, v19, v29
    v_dot2_f32_bf16 v30, v105, v13, v30
    v_dot2_f32_bf16 v31, v111, v19, v31
    s_nop 0
    v_add_f32 v28, v28, v29
    s_nop 0
    v_add_f32 v30, v30, v31
    v_add_f32_dpp v28, v28, v28 quad_perm:[1,0,3,2] row_mask:0xf bank_mask:0xf
    s_nop 0
    v_add_f32_dpp v30, v30, v30 quad_perm:[1,0,3,2] row_mask:0xf bank_mask:0xf
    v_add_f32_dpp v28, v28, v28 quad_perm:[2,3,0,1] row_mask:0xf bank_mask:0xf
    s_nop 0
    v_add_f32_dpp v30, v30, v30 quad_perm:[2,3,0,1] row_mask:0xf bank_mask:0xf
    v_add_f32_dpp v28, v28, v28 row_half_mirror row_mask:0xf bank_mask:0xf
    s_nop 0
    v_add_f32_dpp v30, v30, v30 row_half_mirror row_mask:0xf bank_mask:0xf
    v_cvt_pk_bf16_f32 v28, v28, v30
    v_lshlrev_b32 v29, 16, v28
    v_and_b32 v30, 0xffff0000, v28
    v_mul_f32 v29, 0x3d93cd3a, v29
    v_mul_f32 v30, 0x3d93cd3a, v30
    v_cvt_pk_bf16_f32 v28, v29, v30
    ds_write_b32 v2, v28 offset:32
    v_dot2_f32_bf16 v28, v112, v8, 0
    v_dot2_f32_bf16 v29, v118, v14, 0
    v_dot2_f32_bf16 v30, v124, v8, 0
    v_dot2_f32_bf16 v31, v130, v14, 0
    v_dot2_f32_bf16 v28, v113, v9, v28
    v_dot2_f32_bf16 v29, v119, v15, v29
    v_dot2_f32_bf16 v30, v125, v9, v30
    v_dot2_f32_bf16 v31, v131, v15, v31
    v_dot2_f32_bf16 v28, v114, v10, v28
    v_dot2_f32_bf16 v29, v120, v16, v29
    v_dot2_f32_bf16 v30, v126, v10, v30
    v_dot2_f32_bf16 v31, v132, v16, v31
    v_dot2_f32_bf16 v28, v115, v11, v28
    v_dot2_f32_bf16 v29, v121, v17, v29
    v_dot2_f32_bf16 v30, v127, v11, v30
    v_dot2_f32_bf16 v31, v133, v17, v31
    v_dot2_f32_bf16 v28, v116, v12, v28
    v_dot2_f32_bf16 v29, v122, v18, v29
    v_dot2_f32_bf16 v30, v128, v12, v30
    v_dot2_f32_bf16 v31, v134, v18, v31
    v_dot2_f32_bf16 v28, v117, v13, v28
    v_dot2_f32_bf16 v29, v123, v19, v29
    v_dot2_f32_bf16 v30, v129, v13, v30
    v_dot2_f32_bf16 v31, v135, v19, v31
    s_nop 0
    v_add_f32 v28, v28, v29
    s_nop 0
    v_add_f32 v30, v30, v31
    v_add_f32_dpp v28, v28, v28 quad_perm:[1,0,3,2] row_mask:0xf bank_mask:0xf
    s_nop 0
    v_add_f32_dpp v30, v30, v30 quad_perm:[1,0,3,2] row_mask:0xf bank_mask:0xf
    v_add_f32_dpp v28, v28, v28 quad_perm:[2,3,0,1] row_mask:0xf bank_mask:0xf
    s_nop 0
    v_add_f32_dpp v30, v30, v30 quad_perm:[2,3,0,1] row_mask:0xf bank_mask:0xf
    v_add_f32_dpp v28, v28, v28 row_half_mirror row_mask:0xf bank_mask:0xf
    s_nop 0
    v_add_f32_dpp v30, v30, v30 row_half_mirror row_mask:0xf bank_mask:0xf
    v_cvt_pk_bf16_f32 v28, v28, v30
    v_lshlrev_b32 v29, 16, v28
    v_and_b32 v30, 0xffff0000, v28
    v_mul_f32 v29, 0x3d93cd3a, v29
    v_mul_f32 v30, 0x3d93cd3a, v30
    v_cvt_pk_bf16_f32 v28, v29, v30
    ds_write_b32 v2, v28 offset:64
    v_dot2_f32_bf16 v28, v136, v8, 0
    v_dot2_f32_bf16 v29, v142, v14, 0
    v_dot2_f32_bf16 v30, v148, v8, 0
    v_dot2_f32_bf16 v31, v154, v14, 0
    v_dot2_f32_bf16 v28, v137, v9, v28
    v_dot2_f32_bf16 v29, v143, v15, v29
    v_dot2_f32_bf16 v30, v149, v9, v30
    v_dot2_f32_bf16 v31, v155, v15, v31
    v_dot2_f32_bf16 v28, v138, v10, v28
    v_dot2_f32_bf16 v29, v144, v16, v29
    v_dot2_f32_bf16 v30, v150, v10, v30
    v_dot2_f32_bf16 v31, v156, v16, v31
    v_dot2_f32_bf16 v28, v139, v11, v28
    v_dot2_f32_bf16 v29, v145, v17, v29
    v_dot2_f32_bf16 v30, v151, v11, v30
    v_dot2_f32_bf16 v31, v157, v17, v31
    v_dot2_f32_bf16 v28, v140, v12, v28
    v_dot2_f32_bf16 v29, v146, v18, v29
    v_dot2_f32_bf16 v30, v152, v12, v30
    v_dot2_f32_bf16 v31, v158, v18, v31
    v_dot2_f32_bf16 v28, v141, v13, v28
    v_dot2_f32_bf16 v29, v147, v19, v29
    v_dot2_f32_bf16 v30, v153, v13, v30
    v_dot2_f32_bf16 v31, v159, v19, v31
    s_nop 0
    v_add_f32 v28, v28, v29
    s_nop 0
    v_add_f32 v30, v30, v31
    v_add_f32_dpp v28, v28, v28 quad_perm:[1,0,3,2] row_mask:0xf bank_mask:0xf
    s_nop 0
    v_add_f32_dpp v30, v30, v30 quad_perm:[1,0,3,2] row_mask:0xf bank_mask:0xf
    v_add_f32_dpp v28, v28, v28 quad_perm:[2,3,0,1] row_mask:0xf bank_mask:0xf
    s_nop 0
    v_add_f32_dpp v30, v30, v30 quad_perm:[2,3,0,1] row_mask:0xf bank_mask:0xf
    v_add_f32_dpp v28, v28, v28 row_half_mirror row_mask:0xf bank_mask:0xf
    s_nop 0
    v_add_f32_dpp v30, v30, v30 row_half_mirror row_mask:0xf bank_mask:0xf
    v_cvt_pk_bf16_f32 v28, v28, v30
    v_lshlrev_b32 v29, 16, v28
    v_and_b32 v30, 0xffff0000, v28
    v_mul_f32 v29, 0x3d93cd3a, v29
    v_mul_f32 v30, 0x3d93cd3a, v30
    v_cvt_pk_bf16_f32 v28, v29, v30
    ds_write_b32 v2, v28 offset:96
    s_add_u32 s83, s85, 1966080
    s_waitcnt vmcnt(0)
    buffer_load_dwordx4 v[88:91], v1, s[8:11], s83 offen offset:0 nt
    buffer_load_dwordx4 v[92:95], v1, s[8:11], s83 offen offset:128 nt
    buffer_load_dwordx4 v[96:99], v1, s[8:11], s83 offen offset:256 nt
    buffer_load_dwordx4 v[100:103], v1, s[8:11], s83 offen offset:3072 nt
    buffer_load_dwordx4 v[104:107], v1, s[8:11], s83 offen offset:3200 nt
    buffer_load_dwordx4 v[108:111], v1, s[8:11], s83 offen offset:3328 nt
    v_dot2_f32_bf16 v28, v160, v8, 0
    v_dot2_f32_bf16 v29, v166, v14, 0
    v_dot2_f32_bf16 v30, v172, v8, 0
    v_dot2_f32_bf16 v31, v178, v14, 0
    v_dot2_f32_bf16 v28, v161, v9, v28
    v_dot2_f32_bf16 v29, v167, v15, v29
    v_dot2_f32_bf16 v30, v173, v9, v30
    v_dot2_f32_bf16 v31, v179, v15, v31
    v_dot2_f32_bf16 v28, v162, v10, v28
    v_dot2_f32_bf16 v29, v168, v16, v29
    v_dot2_f32_bf16 v30, v174, v10, v30
    v_dot2_f32_bf16 v31, v180, v16, v31
    v_dot2_f32_bf16 v28, v163, v11, v28
    v_dot2_f32_bf16 v29, v169, v17, v29
    v_dot2_f32_bf16 v30, v175, v11, v30
    v_dot2_f32_bf16 v31, v181, v17, v31
    v_dot2_f32_bf16 v28, v164, v12, v28
    v_dot2_f32_bf16 v29, v170, v18, v29
    v_dot2_f32_bf16 v30, v176, v12, v30
    v_dot2_f32_bf16 v31, v182, v18, v31
    v_dot2_f32_bf16 v28, v165, v13, v28
    v_dot2_f32_bf16 v29, v171, v19, v29
    v_dot2_f32_bf16 v30, v177, v13, v30
    v_dot2_f32_bf16 v31, v183, v19, v31
    s_nop 0
    v_add_f32 v28, v28, v29
    s_nop 0
    v_add_f32 v30, v30, v31
    v_add_f32_dpp v28, v28, v28 quad_perm:[1,0,3,2] row_mask:0xf bank_mask:0xf
    s_nop 0
    v_add_f32_dpp v30, v30, v30 quad_perm:[1,0,3,2] row_mask:0xf bank_mask:0xf
    v_add_f32_dpp v28, v28, v28 quad_perm:[2,3,0,1] row_mask:0xf bank_mask:0xf
    s_nop 0
    v_add_f32_dpp v30, v30, v30 quad_perm:[2,3,0,1] row_mask:0xf bank_mask:0xf
    v_add_f32_dpp v28, v28, v28 row_half_mirror row_mask:0xf bank_mask:0xf
    s_nop 0
    v_add_f32_dpp v30, v30, v30 row_half_mirror row_mask:0xf bank_mask:0xf
    v_cvt_pk_bf16_f32 v28, v28, v30
    v_lshlrev_b32 v29, 16, v28
    v_and_b32 v30, 0xffff0000, v28
    v_mul_f32 v29, 0x3d93cd3a, v29
    v_mul_f32 v30, 0x3d93cd3a, v30
    v_cvt_pk_bf16_f32 v28, v29, v30
    ds_write_b32 v2, v28 offset:128
    v_dot2_f32_bf16 v28, v184, v8, 0
    v_dot2_f32_bf16 v29, v190, v14, 0
    v_dot2_f32_bf16 v30, v196, v8, 0
    v_dot2_f32_bf16 v31, v202, v14, 0
    v_dot2_f32_bf16 v28, v185, v9, v28
    v_dot2_f32_bf16 v29, v191, v15, v29
    v_dot2_f32_bf16 v30, v197, v9, v30
    v_dot2_f32_bf16 v31, v203, v15, v31
    v_dot2_f32_bf16 v28, v186, v10, v28
    v_dot2_f32_bf16 v29, v192, v16, v29
    v_dot2_f32_bf16 v30, v198, v10, v30
    v_dot2_f32_bf16 v31, v204, v16, v31
    v_dot2_f32_bf16 v28, v187, v11, v28
    v_dot2_f32_bf16 v29, v193, v17, v29
    v_dot2_f32_bf16 v30, v199, v11, v30
    v_dot2_f32_bf16 v31, v205, v17, v31
    v_dot2_f32_bf16 v28, v188, v12, v28
    v_dot2_f32_bf16 v29, v194, v18, v29
    v_dot2_f32_bf16 v30, v200, v12, v30
    v_dot2_f32_bf16 v31, v206, v18, v31
    v_dot2_f32_bf16 v28, v189, v13, v28
    v_dot2_f32_bf16 v29, v195, v19, v29
    v_dot2_f32_bf16 v30, v201, v13, v30
    v_dot2_f32_bf16 v31, v207, v19, v31
    s_nop 0
    v_add_f32 v28, v28, v29
    s_nop 0
    v_add_f32 v30, v30, v31
    v_add_f32_dpp v28, v28, v28 quad_perm:[1,0,3,2] row_mask:0xf bank_mask:0xf
    s_nop 0
    v_add_f32_dpp v30, v30, v30 quad_perm:[1,0,3,2] row_mask:0xf bank_mask:0xf
    v_add_f32_dpp v28, v28, v28 quad_perm:[2,3,0,1] row_mask:0xf bank_mask:0xf
    s_nop 0
    v_add_f32_dpp v30, v30, v30 quad_perm:[2,3,0,1] row_mask:0xf bank_mask:0xf
    v_add_f32_dpp v28, v28, v28 row_half_mirror row_mask:0xf bank_mask:0xf
    s_nop 0
    v_add_f32_dpp v30, v30, v30 row_half_mirror row_mask:0xf bank_mask:0xf
    v_cvt_pk_bf16_f32 v28, v28, v30
    v_lshlrev_b32 v29, 16, v28
    v_and_b32 v30, 0xffff0000, v28
    v_mul_f32 v29, 0x3d93cd3a, v29
    v_mul_f32 v30, 0x3d93cd3a, v30
    v_cvt_pk_bf16_f32 v28, v29, v30
    ds_write_b32 v2, v28 offset:160
    v_dot2_f32_bf16 v28, v208, v8, 0
    v_dot2_f32_bf16 v29, v214, v14, 0
    v_dot2_f32_bf16 v30, v220, v8, 0
    v_dot2_f32_bf16 v31, v226, v14, 0
    v_dot2_f32_bf16 v28, v209, v9, v28
    v_dot2_f32_bf16 v29, v215, v15, v29
    v_dot2_f32_bf16 v30, v221, v9, v30
    v_dot2_f32_bf16 v31, v227, v15, v31
    v_dot2_f32_bf16 v28, v210, v10, v28
    v_dot2_f32_bf16 v29, v216, v16, v29
    v_dot2_f32_bf16 v30, v222, v10, v30
    v_dot2_f32_bf16 v31, v228, v16, v31
    v_dot2_f32_bf16 v28, v211, v11, v28
    v_dot2_f32_bf16 v29, v217, v17, v29
    v_dot2_f32_bf16 v30, v223, v11, v30
    v_dot2_f32_bf16 v31, v229, v17, v31
    v_dot2_f32_bf16 v28, v212, v12, v28
    v_dot2_f32_bf16 v29, v218, v18, v29
    v_dot2_f32_bf16 v30, v224, v12, v30
    v_dot2_f32_bf16 v31, v230, v18, v31
    v_dot2_f32_bf16 v28, v213, v13, v28
    v_dot2_f32_bf16 v29, v219, v19, v29
    v_dot2_f32_bf16 v30, v225, v13, v30
    v_dot2_f32_bf16 v31, v231, v19, v31
    s_nop 0
    v_add_f32 v28, v28, v29
    s_nop 0
    v_add_f32 v30, v30, v31
    v_add_f32_dpp v28, v28, v28 quad_perm:[1,0,3,2] row_mask:0xf bank_mask:0xf
    s_nop 0
    v_add_f32_dpp v30, v30, v30 quad_perm:[1,0,3,2] row_mask:0xf bank_mask:0xf
    v_add_f32_dpp v28, v28, v28 quad_perm:[2,3,0,1] row_mask:0xf bank_mask:0xf
    s_nop 0
    v_add_f32_dpp v30, v30, v30 quad_perm:[2,3,0,1] row_mask:0xf bank_mask:0xf
    v_add_f32_dpp v28, v28, v28 row_half_mirror row_mask:0xf bank_mask:0xf
    s_nop 0
    v_add_f32_dpp v30, v30, v30 row_half_mirror row_mask:0xf bank_mask:0xf
    v_cvt_pk_bf16_f32 v28, v28, v30
    v_lshlrev_b32 v29, 16, v28
    v_and_b32 v30, 0xffff0000, v28
    v_mul_f32 v29, 0x3d93cd3a, v29
    v_mul_f32 v30, 0x3d93cd3a, v30
    v_cvt_pk_bf16_f32 v28, v29, v30
    ds_write_b32 v2, v28 offset:192
    s_add_u32 s83, s85, 2162688
    s_waitcnt vmcnt(0)
    buffer_load_dwordx4 v[112:115], v1, s[8:11], s83 offen offset:0 nt
    buffer_load_dwordx4 v[116:119], v1, s[8:11], s83 offen offset:128 nt
    buffer_load_dwordx4 v[120:123], v1, s[8:11], s83 offen offset:256 nt
    buffer_load_dwordx4 v[124:127], v1, s[8:11], s83 offen offset:3072 nt
    buffer_load_dwordx4 v[128:131], v1, s[8:11], s83 offen offset:3200 nt
    buffer_load_dwordx4 v[132:135], v1, s[8:11], s83 offen offset:3328 nt
    v_dot2_f32_bf16 v28, v40, v8, 0
    v_dot2_f32_bf16 v29, v46, v14, 0
    v_dot2_f32_bf16 v30, v52, v8, 0
    v_dot2_f32_bf16 v31, v58, v14, 0
    v_dot2_f32_bf16 v28, v41, v9, v28
    v_dot2_f32_bf16 v29, v47, v15, v29
    v_dot2_f32_bf16 v30, v53, v9, v30
    v_dot2_f32_bf16 v31, v59, v15, v31
    v_dot2_f32_bf16 v28, v42, v10, v28
    v_dot2_f32_bf16 v29, v48, v16, v29
    v_dot2_f32_bf16 v30, v54, v10, v30
    v_dot2_f32_bf16 v31, v60, v16, v31
    v_dot2_f32_bf16 v28, v43, v11, v28
    v_dot2_f32_bf16 v29, v49, v17, v29
    v_dot2_f32_bf16 v30, v55, v11, v30
    v_dot2_f32_bf16 v31, v61, v17, v31
    v_dot2_f32_bf16 v28, v44, v12, v28
    v_dot2_f32_bf16 v29, v50, v18, v29
    v_dot2_f32_bf16 v30, v56, v12, v30
    v_dot2_f32_bf16 v31, v62, v18, v31
    v_dot2_f32_bf16 v28, v45, v13, v28
    v_dot2_f32_bf16 v29, v51, v19, v29
    v_dot2_f32_bf16 v30, v57, v13, v30
    v_dot2_f32_bf16 v31, v63, v19, v31
    s_nop 0
    v_add_f32 v28, v28, v29
    s_nop 0
    v_add_f32 v30, v30, v31
    v_add_f32_dpp v28, v28, v28 quad_perm:[1,0,3,2] row_mask:0xf bank_mask:0xf
    s_nop 0
    v_add_f32_dpp v30, v30, v30 quad_perm:[1,0,3,2] row_mask:0xf bank_mask:0xf
    v_add_f32_dpp v28, v28, v28 quad_perm:[2,3,0,1] row_mask:0xf bank_mask:0xf
    s_nop 0
    v_add_f32_dpp v30, v30, v30 quad_perm:[2,3,0,1] row_mask:0xf bank_mask:0xf
    v_add_f32_dpp v28, v28, v28 row_half_mirror row_mask:0xf bank_mask:0xf
    s_nop 0
    v_add_f32_dpp v30, v30, v30 row_half_mirror row_mask:0xf bank_mask:0xf
    v_cvt_pk_bf16_f32 v28, v28, v30
    v_lshlrev_b32 v29, 16, v28
    v_and_b32 v30, 0xffff0000, v28
    v_mul_f32 v29, 0x3d93cd3a, v29
    v_mul_f32 v30, 0x3d93cd3a, v30
    v_cvt_pk_bf16_f32 v28, v29, v30
    ds_write_b32 v2, v28 offset:256
    v_dot2_f32_bf16 v28, v232, v8, 0
    v_dot2_f32_bf16 v29, v238, v14, 0
    v_dot2_f32_bf16 v30, v244, v8, 0
    v_dot2_f32_bf16 v31, v250, v14, 0
    v_dot2_f32_bf16 v28, v233, v9, v28
    v_dot2_f32_bf16 v29, v239, v15, v29
    v_dot2_f32_bf16 v30, v245, v9, v30
    v_dot2_f32_bf16 v31, v251, v15, v31
    v_dot2_f32_bf16 v28, v234, v10, v28
    v_dot2_f32_bf16 v29, v240, v16, v29
    v_dot2_f32_bf16 v30, v246, v10, v30
    v_dot2_f32_bf16 v31, v252, v16, v31
    v_dot2_f32_bf16 v28, v235, v11, v28
    v_dot2_f32_bf16 v29, v241, v17, v29
    v_dot2_f32_bf16 v30, v247, v11, v30
    v_dot2_f32_bf16 v31, v253, v17, v31
    v_dot2_f32_bf16 v28, v236, v12, v28
    v_dot2_f32_bf16 v29, v242, v18, v29
    v_dot2_f32_bf16 v30, v248, v12, v30
    v_dot2_f32_bf16 v31, v254, v18, v31
    v_dot2_f32_bf16 v28, v237, v13, v28
    v_dot2_f32_bf16 v29, v243, v19, v29
    v_dot2_f32_bf16 v30, v249, v13, v30
    v_dot2_f32_bf16 v31, v255, v19, v31
    s_nop 0
    v_add_f32 v28, v28, v29
    s_nop 0
    v_add_f32 v30, v30, v31
    v_add_f32_dpp v28, v28, v28 quad_perm:[1,0,3,2] row_mask:0xf bank_mask:0xf
    s_nop 0
    v_add_f32_dpp v30, v30, v30 quad_perm:[1,0,3,2] row_mask:0xf bank_mask:0xf
    v_add_f32_dpp v28, v28, v28 quad_perm:[2,3,0,1] row_mask:0xf bank_mask:0xf
    s_nop 0
    v_add_f32_dpp v30, v30, v30 quad_perm:[2,3,0,1] row_mask:0xf bank_mask:0xf
    v_add_f32_dpp v28, v28, v28 row_half_mirror row_mask:0xf bank_mask:0xf
    s_nop 0
    v_add_f32_dpp v30, v30, v30 row_half_mirror row_mask:0xf bank_mask:0xf
    v_cvt_pk_bf16_f32 v28, v28, v30
    v_lshlrev_b32 v29, 16, v28
    v_and_b32 v30, 0xffff0000, v28
    v_mul_f32 v29, 0x3d93cd3a, v29
    v_mul_f32 v30, 0x3d93cd3a, v30
    v_cvt_pk_bf16_f32 v28, v29, v30
    ds_write_b32 v2, v28 offset:224
    v_dot2_f32_bf16 v28, v64, v8, 0
    v_dot2_f32_bf16 v29, v70, v14, 0
    v_dot2_f32_bf16 v30, v76, v8, 0
    v_dot2_f32_bf16 v31, v82, v14, 0
    v_dot2_f32_bf16 v28, v65, v9, v28
    v_dot2_f32_bf16 v29, v71, v15, v29
    v_dot2_f32_bf16 v30, v77, v9, v30
    v_dot2_f32_bf16 v31, v83, v15, v31
    v_dot2_f32_bf16 v28, v66, v10, v28
    v_dot2_f32_bf16 v29, v72, v16, v29
    v_dot2_f32_bf16 v30, v78, v10, v30
    v_dot2_f32_bf16 v31, v84, v16, v31
    v_dot2_f32_bf16 v28, v67, v11, v28
    v_dot2_f32_bf16 v29, v73, v17, v29
    v_dot2_f32_bf16 v30, v79, v11, v30
    v_dot2_f32_bf16 v31, v85, v17, v31
    v_dot2_f32_bf16 v28, v68, v12, v28
    v_dot2_f32_bf16 v29, v74, v18, v29
    v_dot2_f32_bf16 v30, v80, v12, v30
    v_dot2_f32_bf16 v31, v86, v18, v31
    v_dot2_f32_bf16 v28, v69, v13, v28
    v_dot2_f32_bf16 v29, v75, v19, v29
    v_dot2_f32_bf16 v30, v81, v13, v30
    v_dot2_f32_bf16 v31, v87, v19, v31
    s_nop 0
    v_add_f32 v28, v28, v29
    s_nop 0
    v_add_f32 v30, v30, v31
    v_add_f32_dpp v28, v28, v28 quad_perm:[1,0,3,2] row_mask:0xf bank_mask:0xf
    s_nop 0
    v_add_f32_dpp v30, v30, v30 quad_perm:[1,0,3,2] row_mask:0xf bank_mask:0xf
    v_add_f32_dpp v28, v28, v28 quad_perm:[2,3,0,1] row_mask:0xf bank_mask:0xf
    s_nop 0
    v_add_f32_dpp v30, v30, v30 quad_perm:[2,3,0,1] row_mask:0xf bank_mask:0xf
    v_add_f32_dpp v28, v28, v28 row_half_mirror row_mask:0xf bank_mask:0xf
    s_nop 0
    v_add_f32_dpp v30, v30, v30 row_half_mirror row_mask:0xf bank_mask:0xf
    v_cvt_pk_bf16_f32 v28, v28, v30
    v_lshlrev_b32 v29, 16, v28
    v_and_b32 v30, 0xffff0000, v28
    v_mul_f32 v29, 0x3d93cd3a, v29
    v_mul_f32 v30, 0x3d93cd3a, v30
    v_cvt_pk_bf16_f32 v28, v29, v30
    ds_write_b32 v2, v28 offset:288
    s_add_u32 s82, s85, 2359296
    s_waitcnt vmcnt(0)
    buffer_load_dwordx4 v[40:43], v1, s[8:11], s82 offen offset:0 nt
    buffer_load_dwordx4 v[44:47], v1, s[8:11], s82 offen offset:128 nt
    buffer_load_dwordx4 v[48:51], v1, s[8:11], s82 offen offset:256 nt
    buffer_load_dwordx4 v[52:55], v1, s[8:11], s82 offen offset:3072 nt
    buffer_load_dwordx4 v[56:59], v1, s[8:11], s82 offen offset:3200 nt
    buffer_load_dwordx4 v[60:63], v1, s[8:11], s82 offen offset:3328 nt
    v_dot2_f32_bf16 v28, v88, v8, 0
    v_dot2_f32_bf16 v29, v94, v14, 0
    v_dot2_f32_bf16 v30, v100, v8, 0
    v_dot2_f32_bf16 v31, v106, v14, 0
    v_dot2_f32_bf16 v28, v89, v9, v28
    v_dot2_f32_bf16 v29, v95, v15, v29
    v_dot2_f32_bf16 v30, v101, v9, v30
    v_dot2_f32_bf16 v31, v107, v15, v31
    v_dot2_f32_bf16 v28, v90, v10, v28
    v_dot2_f32_bf16 v29, v96, v16, v29
    v_dot2_f32_bf16 v30, v102, v10, v30
    v_dot2_f32_bf16 v31, v108, v16, v31
    v_dot2_f32_bf16 v28, v91, v11, v28
    v_dot2_f32_bf16 v29, v97, v17, v29
    v_dot2_f32_bf16 v30, v103, v11, v30
    v_dot2_f32_bf16 v31, v109, v17, v31
    v_dot2_f32_bf16 v28, v92, v12, v28
    v_dot2_f32_bf16 v29, v98, v18, v29
    v_dot2_f32_bf16 v30, v104, v12, v30
    v_dot2_f32_bf16 v31, v110, v18, v31
    v_dot2_f32_bf16 v28, v93, v13, v28
    v_dot2_f32_bf16 v29, v99, v19, v29
    v_dot2_f32_bf16 v30, v105, v13, v30
    v_dot2_f32_bf16 v31, v111, v19, v31
    s_nop 0
    v_add_f32 v28, v28, v29
    s_nop 0
    v_add_f32 v30, v30, v31
    v_add_f32_dpp v28, v28, v28 quad_perm:[1,0,3,2] row_mask:0xf bank_mask:0xf
    s_nop 0
    v_add_f32_dpp v30, v30, v30 quad_perm:[1,0,3,2] row_mask:0xf bank_mask:0xf
    v_add_f32_dpp v28, v28, v28 quad_perm:[2,3,0,1] row_mask:0xf bank_mask:0xf
    s_nop 0
    v_add_f32_dpp v30, v30, v30 quad_perm:[2,3,0,1] row_mask:0xf bank_mask:0xf
    v_add_f32_dpp v28, v28, v28 row_half_mirror row_mask:0xf bank_mask:0xf
    s_nop 0
    v_add_f32_dpp v30, v30, v30 row_half_mirror row_mask:0xf bank_mask:0xf
    v_cvt_pk_bf16_f32 v28, v28, v30
    v_lshlrev_b32 v29, 16, v28
    v_and_b32 v30, 0xffff0000, v28
    v_mul_f32 v29, 0x3d93cd3a, v29
    v_mul_f32 v30, 0x3d93cd3a, v30
    v_cvt_pk_bf16_f32 v28, v29, v30
    ds_write_b32 v2, v28 offset:320
    v_dot2_f32_bf16 v28, v112, v8, 0
    v_dot2_f32_bf16 v29, v118, v14, 0
    v_dot2_f32_bf16 v30, v124, v8, 0
    v_dot2_f32_bf16 v31, v130, v14, 0
    v_dot2_f32_bf16 v28, v113, v9, v28
    v_dot2_f32_bf16 v29, v119, v15, v29
    v_dot2_f32_bf16 v30, v125, v9, v30
    v_dot2_f32_bf16 v31, v131, v15, v31
    v_dot2_f32_bf16 v28, v114, v10, v28
    v_dot2_f32_bf16 v29, v120, v16, v29
    v_dot2_f32_bf16 v30, v126, v10, v30
    v_dot2_f32_bf16 v31, v132, v16, v31
    v_dot2_f32_bf16 v28, v115, v11, v28
    v_dot2_f32_bf16 v29, v121, v17, v29
    v_dot2_f32_bf16 v30, v127, v11, v30
    v_dot2_f32_bf16 v31, v133, v17, v31
    v_dot2_f32_bf16 v28, v116, v12, v28
    v_dot2_f32_bf16 v29, v122, v18, v29
    v_dot2_f32_bf16 v30, v128, v12, v30
    v_dot2_f32_bf16 v31, v134, v18, v31
    v_dot2_f32_bf16 v28, v117, v13, v28
    v_dot2_f32_bf16 v29, v123, v19, v29
    v_dot2_f32_bf16 v30, v129, v13, v30
    v_dot2_f32_bf16 v31, v135, v19, v31
    s_nop 0
    v_add_f32 v28, v28, v29
    s_nop 0
    v_add_f32 v30, v30, v31
    v_add_f32_dpp v28, v28, v28 quad_perm:[1,0,3,2] row_mask:0xf bank_mask:0xf
    s_nop 0
    v_add_f32_dpp v30, v30, v30 quad_perm:[1,0,3,2] row_mask:0xf bank_mask:0xf
    v_add_f32_dpp v28, v28, v28 quad_perm:[2,3,0,1] row_mask:0xf bank_mask:0xf
    s_nop 0
    v_add_f32_dpp v30, v30, v30 quad_perm:[2,3,0,1] row_mask:0xf bank_mask:0xf
    v_add_f32_dpp v28, v28, v28 row_half_mirror row_mask:0xf bank_mask:0xf
    s_nop 0
    v_add_f32_dpp v30, v30, v30 row_half_mirror row_mask:0xf bank_mask:0xf
    v_cvt_pk_bf16_f32 v28, v28, v30
    v_lshlrev_b32 v29, 16, v28
    v_and_b32 v30, 0xffff0000, v28
    v_mul_f32 v29, 0x3d93cd3a, v29
    v_mul_f32 v30, 0x3d93cd3a, v30
    v_cvt_pk_bf16_f32 v28, v29, v30
    ds_write_b32 v2, v28 offset:352
    v_add_u32 v2, 384, v2
    s_mov_b32 s84, 6
L_k:
    s_add_u32 s83, s82, 196608
    s_waitcnt vmcnt(0)
    buffer_load_dwordx4 v[64:67], v1, s[8:11], s83 offen offset:0 nt
    buffer_load_dwordx4 v[68:71], v1, s[8:11], s83 offen offset:128 nt
    buffer_load_dwordx4 v[72:75], v1, s[8:11], s83 offen offset:256 nt
    buffer_load_dwordx4 v[76:79], v1, s[8:11], s83 offen offset:3072 nt
    buffer_load_dwordx4 v[80:83], v1, s[8:11], s83 offen offset:3200 nt
    buffer_load_dwordx4 v[84:87], v1, s[8:11], s83 offen offset:3328 nt
    v_dot2_f32_bf16 v28, v40, v8, 0
    v_dot2_f32_bf16 v29, v46, v14, 0
    v_dot2_f32_bf16 v30, v52, v8, 0
    v_dot2_f32_bf16 v31, v58, v14, 0
    v_dot2_f32_bf16 v28, v41, v9, v28
    v_dot2_f32_bf16 v29, v47, v15, v29
    v_dot2_f32_bf16 v30, v53, v9, v30
    v_dot2_f32_bf16 v31, v59, v15, v31
    v_dot2_f32_bf16 v28, v42, v10, v28
    v_dot2_f32_bf16 v29, v48, v16, v29
    v_dot2_f32_bf16 v30, v54, v10, v30
    v_dot2_f32_bf16 v31, v60, v16, v31
    v_dot2_f32_bf16 v28, v43, v11, v28
    v_dot2_f32_bf16 v29, v49, v17, v29
    v_dot2_f32_bf16 v30, v55, v11, v30
    v_dot2_f32_bf16 v31, v61, v17, v31
    v_dot2_f32_bf16 v28, v44, v12, v28
    v_dot2_f32_bf16 v29, v50, v18, v29
    v_dot2_f32_bf16 v30, v56, v12, v30
    v_dot2_f32_bf16 v31, v62, v18, v31
    v_dot2_f32_bf16 v28, v45, v13, v28
    v_dot2_f32_bf16 v29, v51, v19, v29
    v_dot2_f32_bf16 v30, v57, v13, v30
    v_dot2_f32_bf16 v31, v63, v19, v31
    s_nop 0
    v_add_f32 v28, v28, v29
    s_nop 0
    v_add_f32 v30, v30, v31
    v_add_f32_dpp v28, v28, v28 quad_perm:[1,0,3,2] row_mask:0xf bank_mask:0xf
    s_nop 0
    v_add_f32_dpp v30, v30, v30 quad_perm:[1,0,3,2] row_mask:0xf bank_mask:0xf
    v_add_f32_dpp v28, v28, v28 quad_perm:[2,3,0,1] row_mask:0xf bank_mask:0xf
    s_nop 0
    v_add_f32_dpp v30, v30, v30 quad_perm:[2,3,0,1] row_mask:0xf bank_mask:0xf
    v_add_f32_dpp v28, v28, v28 row_half_mirror row_mask:0xf bank_mask:0xf
    s_nop 0
    v_add_f32_dpp v30, v30, v30 row_half_mirror row_mask:0xf bank_mask:0xf
    v_cvt_pk_bf16_f32 v28, v28, v30
    v_lshlrev_b32 v29, 16, v28
    v_and_b32 v30, 0xffff0000, v28
    v_mul_f32 v29, 0x3d93cd3a, v29
    v_mul_f32 v30, 0x3d93cd3a, v30
    v_cvt_pk_bf16_f32 v28, v29, v30
    ds_write_b32 v2, v28 offset:0
    s_add_u32 s84, s84, 1
    s_and_b32 s6, s84, 7
    s_cmp_eq_u32 s6, 0
    s_cselect_b32 s7, 97910784, s88
    s_add_u32 s82, s82, s7
    s_cmp_eq_u32 s84, 31
    s_cbranch_scc1 L_k_last
    s_waitcnt vmcnt(0)
    buffer_load_dwordx4 v[40:43], v1, s[8:11], s82 offen offset:0 nt
    buffer_load_dwordx4 v[44:47], v1, s[8:11], s82 offen offset:128 nt
    buffer_load_dwordx4 v[48:51], v1, s[8:11], s82 offen offset:256 nt
    buffer_load_dwordx4 v[52:55], v1, s[8:11], s82 offen offset:3072 nt
    buffer_load_dwordx4 v[56:59], v1, s[8:11], s82 offen offset:3200 nt
    buffer_load_dwordx4 v[60:63], v1, s[8:11], s82 offen offset:3328 nt
    v_dot2_f32_bf16 v28, v64, v8, 0
    v_dot2_f32_bf16 v29, v70, v14, 0
    v_dot2_f32_bf16 v30, v76, v8, 0
    v_dot2_f32_bf16 v31, v82, v14, 0
    v_dot2_f32_bf16 v28, v65, v9, v28
    v_dot2_f32_bf16 v29, v71, v15, v29
    v_dot2_f32_bf16 v30, v77, v9, v30
    v_dot2_f32_bf16 v31, v83, v15, v31
    v_dot2_f32_bf16 v28, v66, v10, v28
    v_dot2_f32_bf16 v29, v72, v16, v29
    v_dot2_f32_bf16 v30, v78, v10, v30
    v_dot2_f32_bf16 v31, v84, v16, v31
    v_dot2_f32_bf16 v28, v67, v11, v28
    v_dot2_f32_bf16 v29, v73, v17, v29
    v_dot2_f32_bf16 v30, v79, v11, v30
    v_dot2_f32_bf16 v31, v85, v17, v31
    v_dot2_f32_bf16 v28, v68, v12, v28
    v_dot2_f32_bf16 v29, v74, v18, v29
    v_dot2_f32_bf16 v30, v80, v12, v30
    v_dot2_f32_bf16 v31, v86, v18, v31
    v_dot2_f32_bf16 v28, v69, v13, v28
    v_dot2_f32_bf16 v29, v75, v19, v29
    v_dot2_f32_bf16 v30, v81, v13, v30
    v_dot2_f32_bf16 v31, v87, v19, v31
    s_nop 0
    v_add_f32 v28, v28, v29
    s_nop 0
    v_add_f32 v30, v30, v31
    v_add_f32_dpp v28, v28, v28 quad_perm:[1,0,3,2] row_mask:0xf bank_mask:0xf
    s_nop 0
    v_add_f32_dpp v30, v30, v30 quad_perm:[1,0,3,2] row_mask:0xf bank_mask:0xf
    v_add_f32_dpp v28, v28, v28 quad_perm:[2,3,0,1] row_mask:0xf bank_mask:0xf
    s_nop 0
    v_add_f32_dpp v30, v30, v30 quad_perm:[2,3,0,1] row_mask:0xf bank_mask:0xf
    v_add_f32_dpp v28, v28, v28 row_half_mirror row_mask:0xf bank_mask:0xf
    s_nop 0
    v_add_f32_dpp v30, v30, v30 row_half_mirror row_mask:0xf bank_mask:0xf
    v_cvt_pk_bf16_f32 v28, v28, v30
    v_lshlrev_b32 v29, 16, v28
    v_and_b32 v30, 0xffff0000, v28
    v_mul_f32 v29, 0x3d93cd3a, v29
    v_mul_f32 v30, 0x3d93cd3a, v30
    v_cvt_pk_bf16_f32 v28, v29, v30
    ds_write_b32 v2, v28 offset:32
    v_add_u32 v2, 64, v2
    s_cmp_lg_u32 s6, 0
    s_cbranch_scc1 L_k
    s_mov_b64 exec, 1
    ds_add_u32 v32, v33
    s_mov_b64 exec, -1
    v_add_u32 v32, 4, v32
    ds_read_b128 v[8:11], v34 offset:0
    ds_read_b128 v[12:15], v34 offset:128
    ds_read_b128 v[16:19], v34 offset:256
    v_add_u32 v34, 384, v34
    s_waitcnt lgkmcnt(0)
    s_branch L_k
L_k_last:
    s_add_u32 s83, s82, 196608
    s_waitcnt vmcnt(0)
    buffer_load_dwordx4 v[40:43], v1, s[8:11], s82 offen offset:0 nt
    buffer_load_dwordx4 v[44:47], v1, s[8:11], s82 offen offset:128 nt
    buffer_load_dwordx4 v[48:51], v1, s[8:11], s82 offen offset:256 nt
    buffer_load_dwordx4 v[52:55], v1, s[8:11], s82 offen offset:3072 nt
    buffer_load_dwordx4 v[56:59], v1, s[8:11], s82 offen offset:3200 nt
    buffer_load_dwordx4 v[60:63], v1, s[8:11], s82 offen offset:3328 nt
    v_dot2_f32_bf16 v28, v64, v8, 0
    v_dot2_f32_bf16 v29, v70, v14, 0
    v_dot2_f32_bf16 v30, v76, v8, 0
    v_dot2_f32_bf16 v31, v82, v14, 0
    v_dot2_f32_bf16 v28, v65, v9, v28
    v_dot2_f32_bf16 v29, v71, v15, v29
    v_dot2_f32_bf16 v30, v77, v9, v30
    v_dot2_f32_bf16 v31, v83, v15, v31
    v_dot2_f32_bf16 v28, v66, v10, v28
    v_dot2_f32_bf16 v29, v72, v16, v29
    v_dot2_f32_bf16 v30, v78, v10, v30
    v_dot2_f32_bf16 v31, v84, v16, v31
    v_dot2_f32_bf16 v28, v67, v11, v28
    v_dot2_f32_bf16 v29, v73, v17, v29
    v_dot2_f32_bf16 v30, v79, v11, v30
    v_dot2_f32_bf16 v31, v85, v17, v31
    v_dot2_f32_bf16 v28, v68, v12, v28
    v_dot2_f32_bf16 v29, v74, v18, v29
    v_dot2_f32_bf16 v30, v80, v12, v30
    v_dot2_f32_bf16 v31, v86, v18, v31
    v_dot2_f32_bf16 v28, v69, v13, v28
    v_dot2_f32_bf16 v29, v75, v19, v29
    v_dot2_f32_bf16 v30, v81, v13, v30
    v_dot2_f32_bf16 v31, v87, v19, v31
    s_nop 0
    v_add_f32 v28, v28, v29
    s_nop 0
    v_add_f32 v30, v30, v31
    v_add_f32_dpp v28, v28, v28 quad_perm:[1,0,3,2] row_mask:0xf bank_mask:0xf
    s_nop 0
    v_add_f32_dpp v30, v30, v30 quad_perm:[1,0,3,2] row_mask:0xf bank_mask:0xf
    v_add_f32_dpp v28, v28, v28 quad_perm:[2,3,0,1] row_mask:0xf bank_mask:0xf
    s_nop 0
    v_add_f32_dpp v30, v30, v30 quad_perm:[2,3,0,1] row_mask:0xf bank_mask:0xf
    v_add_f32_dpp v28, v28, v28 row_half_mirror row_mask:0xf bank_mask:0xf
    s_nop 0
    v_add_f32_dpp v30, v30, v30 row_half_mirror row_mask:0xf bank_mask:0xf
    v_cvt_pk_bf16_f32 v28, v28, v30
    v_lshlrev_b32 v29, 16, v28
    v_and_b32 v30, 0xffff0000, v28
    v_mul_f32 v29, 0x3d93cd3a, v29
    v_mul_f32 v30, 0x3d93cd3a, v30
    v_cvt_pk_bf16_f32 v28, v29, v30
    ds_write_b32 v2, v28 offset:32
    s_mov_b32 s82, s85
    s_cmp_eq_u32 s89, 1
    s_waitcnt vmcnt(0)
    s_cbranch_scc1 L_kv0
    buffer_load_dwordx4 v[64:67], v1, s[8:11], s83 offen offset:0 nt
    buffer_load_dwordx4 v[68:71], v1, s[8:11], s83 offen offset:128 nt
    buffer_load_dwordx4 v[72:75], v1, s[8:11], s83 offen offset:256 nt
    buffer_load_dwordx4 v[76:79], v1, s[8:11], s83 offen offset:3072 nt
    buffer_load_dwordx4 v[80:83], v1, s[8:11], s83 offen offset:3200 nt
    buffer_load_dwordx4 v[84:87], v1, s[8:11], s83 offen offset:3328 nt
    s_branch L_kc0
L_kv0:
    buffer_load_dwordx4 v[88:91], v1, s[12:15], s82 offen offset:0 nt
    buffer_load_dwordx4 v[92:95], v1, s[12:15], s82 offen offset:128 nt
    buffer_load_dwordx4 v[96:99], v1, s[12:15], s82 offen offset:256 nt
    buffer_load_dwordx4 v[100:103], v1, s[12:15], s82 offen offset:3072 nt
    buffer_load_dwordx4 v[104:107], v1, s[12:15], s82 offen offset:3200 nt
    buffer_load_dwordx4 v[108:111], v1, s[12:15], s82 offen offset:3328 nt
L_kc0:
    v_dot2_f32_bf16 v28, v40, v8, 0
    v_dot2_f32_bf16 v29, v46, v14, 0
    v_dot2_f32_bf16 v30, v52, v8, 0
    v_dot2_f32_bf16 v31, v58, v14, 0
    v_dot2_f32_bf16 v28, v41, v9, v28
    v_dot2_f32_bf16 v29, v47, v15, v29
    v_dot2_f32_bf16 v30, v53, v9, v30
    v_dot2_f32_bf16 v31, v59, v15, v31
    v_dot2_f32_bf16 v28, v42, v10, v28
    v_dot2_f32_bf16 v29, v48, v16, v29
    v_dot2_f32_bf16 v30, v54, v10, v30
    v_dot2_f32_bf16 v31, v60, v16, v31
    v_dot2_f32_bf16 v28, v43, v11, v28
    v_dot2_f32_bf16 v29, v49, v17, v29
    v_dot2_f32_bf16 v30, v55, v11, v30
    v_dot2_f32_bf16 v31, v61, v17, v31
    v_dot2_f32_bf16 v28, v44, v12, v28
    v_dot2_f32_bf16 v29, v50, v18, v29
    v_dot2_f32_bf16 v30, v56, v12, v30
    v_dot2_f32_bf16 v31, v62, v18, v31
    v_dot2_f32_bf16 v28, v45, v13, v28
    v_dot2_f32_bf16 v29, v51, v19, v29
    v_dot2_f32_bf16 v30, v57, v13, v30
    v_dot2_f32_bf16 v31, v63, v19, v31
    s_nop 0
    v_add_f32 v28, v28, v29
    s_nop 0
    v_add_f32 v30, v30, v31
    v_add_f32_dpp v28, v28, v28 quad_perm:[1,0,3,2] row_mask:0xf bank_mask:0xf
    s_nop 0
    v_add_f32_dpp v30, v30, v30 quad_perm:[1,0,3,2] row_mask:0xf bank_mask:0xf
    v_add_f32_dpp v28, v28, v28 quad_perm:[2,3,0,1] row_mask:0xf bank_mask:0xf
    s_nop 0
    v_add_f32_dpp v30, v30, v30 quad_perm:[2,3,0,1] row_mask:0xf bank_mask:0xf
    v_add_f32_dpp v28, v28, v28 row_half_mirror row_mask:0xf bank_mask:0xf
    s_nop 0
    v_add_f32_dpp v30, v30, v30 row_half_mirror row_mask:0xf bank_mask:0xf
    v_cvt_pk_bf16_f32 v28, v28, v30
    v_lshlrev_b32 v29, 16, v28
    v_and_b32 v30, 0xffff0000, v28
    v_mul_f32 v29, 0x3d93cd3a, v29
    v_mul_f32 v30, 0x3d93cd3a, v30
    v_cvt_pk_bf16_f32 v28, v29, v30
    ds_write_b32 v2, v28 offset:64
    s_cbranch_scc1 L_kdone
    s_cmp_eq_u32 s89, 2
    s_waitcnt vmcnt(0)
    s_cbranch_scc1 L_kv1
    buffer_load_dwordx4 v[40:43], v1, s[8:11], s90 offen offset:0 nt
    buffer_load_dwordx4 v[44:47], v1, s[8:11], s90 offen offset:128 nt
    buffer_load_dwordx4 v[48:51], v1, s[8:11], s90 offen offset:256 nt
    buffer_load_dwordx4 v[52:55], v1, s[8:11], s90 offen offset:3072 nt
    buffer_load_dwordx4 v[56:59], v1, s[8:11], s90 offen offset:3200 nt
    buffer_load_dwordx4 v[60:63], v1, s[8:11], s90 offen offset:3328 nt
    s_branch L_kc1
L_kv1:
    buffer_load_dwordx4 v[88:91], v1, s[12:15], s82 offen offset:0 nt
    buffer_load_dwordx4 v[92:95], v1, s[12:15], s82 offen offset:128 nt
    buffer_load_dwordx4 v[96:99], v1, s[12:15], s82 offen offset:256 nt
    buffer_load_dwordx4 v[100:103], v1, s[12:15], s82 offen offset:3072 nt
    buffer_load_dwordx4 v[104:107], v1, s[12:15], s82 offen offset:3200 nt
    buffer_load_dwordx4 v[108:111], v1, s[12:15], s82 offen offset:3328 nt
L_kc1:
    v_dot2_f32_bf16 v28, v64, v8, 0
    v_dot2_f32_bf16 v29, v70, v14, 0
    v_dot2_f32_bf16 v30, v76, v8, 0
    v_dot2_f32_bf16 v31, v82, v14, 0
    v_dot2_f32_bf16 v28, v65, v9, v28
    v_dot2_f32_bf16 v29, v71, v15, v29
    v_dot2_f32_bf16 v30, v77, v9, v30
    v_dot2_f32_bf16 v31, v83, v15, v31
    v_dot2_f32_bf16 v28, v66, v10, v28
    v_dot2_f32_bf16 v29, v72, v16, v29
    v_dot2_f32_bf16 v30, v78, v10, v30
    v_dot2_f32_bf16 v31, v84, v16, v31
    v_dot2_f32_bf16 v28, v67, v11, v28
    v_dot2_f32_bf16 v29, v73, v17, v29
    v_dot2_f32_bf16 v30, v79, v11, v30
    v_dot2_f32_bf16 v31, v85, v17, v31
    v_dot2_f32_bf16 v28, v68, v12, v28
    v_dot2_f32_bf16 v29, v74, v18, v29
    v_dot2_f32_bf16 v30, v80, v12, v30
    v_dot2_f32_bf16 v31, v86, v18, v31
    v_dot2_f32_bf16 v28, v69, v13, v28
    v_dot2_f32_bf16 v29, v75, v19, v29
    v_dot2_f32_bf16 v30, v81, v13, v30
    v_dot2_f32_bf16 v31, v87, v19, v31
    s_nop 0
    v_add_f32 v28, v28, v29
    s_nop 0
    v_add_f32 v30, v30, v31
    v_add_f32_dpp v28, v28, v28 quad_perm:[1,0,3,2] row_mask:0xf bank_mask:0xf
    s_nop 0
    v_add_f32_dpp v30, v30, v30 quad_perm:[1,0,3,2] row_mask:0xf bank_mask:0xf
    v_add_f32_dpp v28, v28, v28 quad_perm:[2,3,0,1] row_mask:0xf bank_mask:0xf
    s_nop 0
    v_add_f32_dpp v30, v30, v30 quad_perm:[2,3,0,1] row_mask:0xf bank_mask:0xf
    v_add_f32_dpp v28, v28, v28 row_half_mirror row_mask:0xf bank_mask:0xf
    s_nop 0
    v_add_f32_dpp v30, v30, v30 row_half_mirror row_mask:0xf bank_mask:0xf
    v_cvt_pk_bf16_f32 v28, v28, v30
    v_lshlrev_b32 v29, 16, v28
    v_and_b32 v30, 0xffff0000, v28
    v_mul_f32 v29, 0x3d93cd3a, v29
    v_mul_f32 v30, 0x3d93cd3a, v30
    v_cvt_pk_bf16_f32 v28, v29, v30
    ds_write_b32 v2, v28 offset:96
    s_cbranch_scc1 L_kdone
    s_waitcnt vmcnt(0)
    buffer_load_dwordx4 v[64:67], v1, s[8:11], s91 offen offset:0 nt
    buffer_load_dwordx4 v[68:71], v1, s[8:11], s91 offen offset:128 nt
    buffer_load_dwordx4 v[72:75], v1, s[8:11], s91 offen offset:256 nt
    buffer_load_dwordx4 v[76:79], v1, s[8:11], s91 offen offset:3072 nt
    buffer_load_dwordx4 v[80:83], v1, s[8:11], s91 offen offset:3200 nt
    buffer_load_dwordx4 v[84:87], v1, s[8:11], s91 offen offset:3328 nt
L_kc2:
    v_dot2_f32_bf16 v28, v40, v8, 0
    v_dot2_f32_bf16 v29, v46, v14, 0
    v_dot2_f32_bf16 v30, v52, v8, 0
    v_dot2_f32_bf16 v31, v58, v14, 0
    v_dot2_f32_bf16 v28, v41, v9, v28
    v_dot2_f32_bf16 v29, v47, v15, v29
    v_dot2_f32_bf16 v30, v53, v9, v30
    v_dot2_f32_bf16 v31, v59, v15, v31
    v_dot2_f32_bf16 v28, v42, v10, v28
    v_dot2_f32_bf16 v29, v48, v16, v29
    v_dot2_f32_bf16 v30, v54, v10, v30
    v_dot2_f32_bf16 v31, v60, v16, v31
    v_dot2_f32_bf16 v28, v43, v11, v28
    v_dot2_f32_bf16 v29, v49, v17, v29
    v_dot2_f32_bf16 v30, v55, v11, v30
    v_dot2_f32_bf16 v31, v61, v17, v31
    v_dot2_f32_bf16 v28, v44, v12, v28
    v_dot2_f32_bf16 v29, v50, v18, v29
    v_dot2_f32_bf16 v30, v56, v12, v30
    v_dot2_f32_bf16 v31, v62, v18, v31
    v_dot2_f32_bf16 v28, v45, v13, v28
    v_dot2_f32_bf16 v29, v51, v19, v29
    v_dot2_f32_bf16 v30, v57, v13, v30
    v_dot2_f32_bf16 v31, v63, v19, v31
    s_nop 0
    v_add_f32 v28, v28, v29
    s_nop 0
    v_add_f32 v30, v30, v31
    v_add_f32_dpp v28, v28, v28 quad_perm:[1,0,3,2] row_mask:0xf bank_mask:0xf
    s_nop 0
    v_add_f32_dpp v30, v30, v30 quad_perm:[1,0,3,2] row_mask:0xf bank_mask:0xf
    v_add_f32_dpp v28, v28, v28 quad_perm:[2,3,0,1] row_mask:0xf bank_mask:0xf
    s_nop 0
    v_add_f32_dpp v30, v30, v30 quad_perm:[2,3,0,1] row_mask:0xf bank_mask:0xf
    v_add_f32_dpp v28, v28, v28 row_half_mirror row_mask:0xf bank_mask:0xf
    s_nop 0
    v_add_f32_dpp v30, v30, v30 row_half_mirror row_mask:0xf bank_mask:0xf
    v_cvt_pk_bf16_f32 v28, v28, v30
    v_lshlrev_b32 v29, 16, v28
    v_and_b32 v30, 0xffff0000, v28
    v_mul_f32 v29, 0x3d93cd3a, v29
    v_mul_f32 v30, 0x3d93cd3a, v30
    v_cvt_pk_bf16_f32 v28, v29, v30
    ds_write_b32 v2, v28 offset:128
    s_waitcnt vmcnt(0)
    buffer_load_dwordx4 v[88:91], v1, s[12:15], s82 offen offset:0 nt
    buffer_load_dwordx4 v[92:95], v1, s[12:15], s82 offen offset:128 nt
    buffer_load_dwordx4 v[96:99], v1, s[12:15], s82 offen offset:256 nt
    buffer_load_dwordx4 v[100:103], v1, s[12:15], s82 offen offset:3072 nt
    buffer_load_dwordx4 v[104:107], v1, s[12:15], s82 offen offset:3200 nt
    buffer_load_dwordx4 v[108:111], v1, s[12:15], s82 offen offset:3328 nt
L_kc3:
    v_dot2_f32_bf16 v28, v64, v8, 0
    v_dot2_f32_bf16 v29, v70, v14, 0
    v_dot2_f32_bf16 v30, v76, v8, 0
    v_dot2_f32_bf16 v31, v82, v14, 0
    v_dot2_f32_bf16 v28, v65, v9, v28
    v_dot2_f32_bf16 v29, v71, v15, v29
    v_dot2_f32_bf16 v30, v77, v9, v30
    v_dot2_f32_bf16 v31, v83, v15, v31
    v_dot2_f32_bf16 v28, v66, v10, v28
    v_dot2_f32_bf16 v29, v72, v16, v29
    v_dot2_f32_bf16 v30, v78, v10, v30
    v_dot2_f32_bf16 v31, v84, v16, v31
    v_dot2_f32_bf16 v28, v67, v11, v28
    v_dot2_f32_bf16 v29, v73, v17, v29
    v_dot2_f32_bf16 v30, v79, v11, v30
    v_dot2_f32_bf16 v31, v85, v17, v31
    v_dot2_f32_bf16 v28, v68, v12, v28
    v_dot2_f32_bf16 v29, v74, v18, v29
    v_dot2_f32_bf16 v30, v80, v12, v30
    v_dot2_f32_bf16 v31, v86, v18, v31
    v_dot2_f32_bf16 v28, v69, v13, v28
    v_dot2_f32_bf16 v29, v75, v19, v29
    v_dot2_f32_bf16 v30, v81, v13, v30
    v_dot2_f32_bf16 v31, v87, v19, v31
    s_nop 0
    v_add_f32 v28, v28, v29
    s_nop 0
    v_add_f32 v30, v30, v31
    v_add_f32_dpp v28, v28, v28 quad_perm:[1,0,3,2] row_mask:0xf bank_mask:0xf
    s_nop 0
    v_add_f32_dpp v30, v30, v30 quad_perm:[1,0,3,2] row_mask:0xf bank_mask:0xf
    v_add_f32_dpp v28, v28, v28 quad_perm:[2,3,0,1] row_mask:0xf bank_mask:0xf
    s_nop 0
    v_add_f32_dpp v30, v30, v30 quad_perm:[2,3,0,1] row_mask:0xf bank_mask:0xf
    v_add_f32_dpp v28, v28, v28 row_half_mirror row_mask:0xf bank_mask:0xf
    s_nop 0
    v_add_f32_dpp v30, v30, v30 row_half_mirror row_mask:0xf bank_mask:0xf
    v_cvt_pk_bf16_f32 v28, v28, v30
    v_lshlrev_b32 v29, 16, v28
    v_and_b32 v30, 0xffff0000, v28
    v_mul_f32 v29, 0x3d93cd3a, v29
    v_mul_f32 v30, 0x3d93cd3a, v30
    v_cvt_pk_bf16_f32 v28, v29, v30
    ds_write_b32 v2, v28 offset:160
L_kdone:
    s_mov_b64 exec, 1
    ds_add_u32 v32, v33
    s_mov_b64 exec, -1
    s_mul_i32 s6, s3, 2112
    s_add_u32 s6, s6, 2048
    v_lshrrev_b32 v2, 3, v0
    v_lshl_add_u32 v2, v2, 2, s6
    v_mov_b32 v32, 32
    v_mov_b32 v31, 4
    v_lshlrev_b32 v34, 4, v0
    v_mov_b32 v8, 0
    v_mov_b32 v9, 0
    v_mov_b32 v10, 0
    v_mov_b32 v11, 0
    v_mov_b32 v12, 0
    v_mov_b32 v13, 0
    v_mov_b32 v14, 0
    v_mov_b32 v15, 0
    v_mov_b32 v16, 0
    v_mov_b32 v17, 0
    v_mov_b32 v18, 0
    v_mov_b32 v19, 0
    s_lshl_b32 s86, s4, 5
    s_add_u32 s86, s86, s5
    s_mul_i32 s86, s86, 768
    s_add_u32 s86, s86, 526592
    s_mov_b32 s84, 0
    s_cmp_eq_u32 s3, 0
    s_cselect_b32 s92, 23, 0
    s_mul_i32 s58, s57, 0x9e3779b1
    s_add_u32 s58, s58, 0x5bd1e995
    s_mov_b32 s59, 0xffffff00
    v_lshrrev_b32 v140, 1, v34
    v_and_b32 v140, 24, v140
    v_bfe_u32 v140, s58, v140, 8
    s_mov_b32 s94, 0x40000
L_stat_3:
    ds_read_b128 v[36:39], v35 offset:64
    s_waitcnt lgkmcnt(0)
    v_readfirstlane_b32 s93, v38
    s_cmp_lg_u32 s93, 0
    s_cbranch_scc1 L_stat_ok_4
    s_sleep 2
    s_sub_u32 s94, s94, 1
    s_cmp_lg_u32 s94, 0
    s_cbranch_scc1 L_stat_3
L_stat_ok_4:
    v_add_u32 v35, 16, v35
    s_sub_u32 s64, s93, 1
    ds_read_b32 v28, v2
    s_waitcnt lgkmcnt(0)
    v_lshlrev_b32 v29, 16, v28
    v_and_b32 v30, 0xffff0000, v28
    v_sub_f32 v29, v29, v36
    v_sub_f32 v30, v30, v36
    v_mul_f32 v29, 0x3fb8aa3b, v29
    v_mul_f32 v30, 0x3fb8aa3b, v30
    v_exp_f32 v29, v29
    v_exp_f32 v30, v30
    v_mul_f32 v29, v29, v37
    v_mul_f32 v30, v30, v37
    v_cvt_pk_bf16_f32 v29, v29, v29
    v_cvt_pk_bf16_f32 v30, v30, v30
    v_and_b32 v20, v29, v4
    v_and_b32 v24, v30, v4
    v_and_b32 v21, v29, v5
    v_and_b32 v25, v30, v5
    v_and_b32 v22, v29, v6
    v_and_b32 v26, v30, v6
    v_and_b32 v23, v29, v7
    v_and_b32 v27, v30, v7
    s_mov_b32 s91, 0
L_v:
    s_add_u32 s6, s84, s91
    s_cmp_ge_u32 s6, 32
    s_cbranch_scc1 L_deep
    s_waitcnt vmcnt(0)
    s_add_u32 s83, s82, 196608
    buffer_load_dwordx4 v[112:115], v1, s[12:15], s83 offen offset:0 nt
    buffer_load_dwordx4 v[116:119], v1, s[12:15], s83 offen offset:128 nt
    buffer_load_dwordx4 v[120:123], v1, s[12:15], s83 offen offset:256 nt
    buffer_load_dwordx4 v[124:127], v1, s[12:15], s83 offen offset:3072 nt
    buffer_load_dwordx4 v[128:131], v1, s[12:15], s83 offen offset:3200 nt
    buffer_load_dwordx4 v[132:135], v1, s[12:15], s83 offen offset:3328 nt
    ds_read_b32 v28, v2 offset:32
    v_mfma_f32_16x16x32_bf16 v[8:11], v[88:91], v[20:23], v[8:11]
    v_mfma_f32_16x16x32_bf16 v[12:15], v[92:95], v[20:23], v[12:15]
    v_mfma_f32_16x16x32_bf16 v[16:19], v[96:99], v[20:23], v[16:19]
    v_mfma_f32_16x16x32_bf16 v[8:11], v[100:103], v[24:27], v[8:11]
    v_mfma_f32_16x16x32_bf16 v[12:15], v[104:107], v[24:27], v[12:15]
    v_mfma_f32_16x16x32_bf16 v[16:19], v[108:111], v[24:27], v[16:19]
    s_mov_b64 exec, 1
    ds_add_u32 v31, v33
    s_mov_b64 exec, -1
    s_waitcnt lgkmcnt(0)
    v_lshlrev_b32 v29, 16, v28
    v_and_b32 v30, 0xffff0000, v28
    v_sub_f32 v29, v29, v36
    v_sub_f32 v30, v30, v36
    v_mul_f32 v29, 0x3fb8aa3b, v29
    v_mul_f32 v30, 0x3fb8aa3b, v30
    v_exp_f32 v29, v29
    v_exp_f32 v30, v30
    v_mul_f32 v29, v29, v37
    v_mul_f32 v30, v30, v37
    v_cvt_pk_bf16_f32 v29, v29, v29
    v_cvt_pk_bf16_f32 v30, v30, v30
    v_and_b32 v20, v29, v4
    v_and_b32 v24, v30, v4
    v_and_b32 v21, v29, v5
    v_and_b32 v25, v30, v5
    v_and_b32 v22, v29, v6
    v_and_b32 v26, v30, v6
    v_and_b32 v23, v29, v7
    v_and_b32 v27, v30, v7
    s_add_u32 s84, s84, 1
    s_and_b32 s6, s84, 7
    s_cmp_eq_u32 s6, 0
    s_cselect_b32 s7, 97910784, s88
    s_add_u32 s82, s82, s7
    v_add_u32 v2, 64, v2
    s_cmp_eq_u32 s84, 31
    s_cbranch_scc1 L_v_last
    s_waitcnt vmcnt(0)
    buffer_load_dwordx4 v[88:91], v1, s[12:15], s82 offen offset:0 nt
    buffer_load_dwordx4 v[92:95], v1, s[12:15], s82 offen offset:128 nt
    buffer_load_dwordx4 v[96:99], v1, s[12:15], s82 offen offset:256 nt
    buffer_load_dwordx4 v[100:103], v1, s[12:15], s82 offen offset:3072 nt
    buffer_load_dwordx4 v[104:107], v1, s[12:15], s82 offen offset:3200 nt
    buffer_load_dwordx4 v[108:111], v1, s[12:15], s82 offen offset:3328 nt
    s_cmp_eq_u32 s84, s92
    s_cbranch_scc1 L_prep
L_prepd:
    v_mfma_f32_16x16x32_bf16 v[8:11], v[112:115], v[20:23], v[8:11]
    v_mfma_f32_16x16x32_bf16 v[12:15], v[116:119], v[20:23], v[12:15]
    v_mfma_f32_16x16x32_bf16 v[16:19], v[120:123], v[20:23], v[16:19]
    v_mfma_f32_16x16x32_bf16 v[8:11], v[124:127], v[24:27], v[8:11]
    v_mfma_f32_16x16x32_bf16 v[12:15], v[128:131], v[24:27], v[12:15]
    v_mfma_f32_16x16x32_bf16 v[16:19], v[132:135], v[24:27], v[16:19]
    s_cmp_eq_u32 s6, 0
    s_cbranch_scc1 L_flush
    ds_read_b32 v28, v2
    ds_read_b32 v141, v31 offset:140
    s_mov_b64 exec, 1
    ds_add_u32 v31, v33
    s_mov_b64 exec, -1
    s_waitcnt lgkmcnt(0)
    v_lshlrev_b32 v29, 16, v28
    v_and_b32 v30, 0xffff0000, v28
    v_sub_f32 v29, v29, v36
    v_sub_f32 v30, v30, v36
    v_mul_f32 v29, 0x3fb8aa3b, v29
    v_mul_f32 v30, 0x3fb8aa3b, v30
    v_exp_f32 v29, v29
    v_exp_f32 v30, v30
    v_mul_f32 v29, v29, v37
    v_mul_f32 v30, v30, v37
    v_cvt_pk_bf16_f32 v29, v29, v29
    v_cvt_pk_bf16_f32 v30, v30, v30
    v_and_b32 v20, v29, v4
    v_and_b32 v24, v30, v4
    v_and_b32 v21, v29, v5
    v_and_b32 v25, v30, v5
    v_and_b32 v22, v29, v6
    v_and_b32 v26, v30, v6
    v_and_b32 v23, v29, v7
    v_and_b32 v27, v30, v7
    v_readfirstlane_b32 s91, v141
    s_branch L_v
L_deep:
    s_add_u32 s83, s82, 196608
    buffer_load_dwordx4 v[112:115], v1, s[12:15], s83 offen offset:0 nt
    buffer_load_dwordx4 v[116:119], v1, s[12:15], s83 offen offset:128 nt
    buffer_load_dwordx4 v[120:123], v1, s[12:15], s83 offen offset:256 nt
    buffer_load_dwordx4 v[124:127], v1, s[12:15], s83 offen offset:3072 nt
    buffer_load_dwordx4 v[128:131], v1, s[12:15], s83 offen offset:3200 nt
    buffer_load_dwordx4 v[132:135], v1, s[12:15], s83 offen offset:3328 nt
L_deep1:
    s_add_u32 s84, s84, 1
    s_add_u32 s82, s82, s88
    s_add_u32 s83, s82, 196608
    s_cmp_eq_u32 s84, 32
    ds_read_b32 v28, v2 offset:32
    s_waitcnt vmcnt(0)
    s_cbranch_scc1 L_deepz1
    buffer_load_dwordx4 v[192:195], v1, s[12:15], s82 offen offset:0 nt
    buffer_load_dwordx4 v[196:199], v1, s[12:15], s82 offen offset:128 nt
    buffer_load_dwordx4 v[200:203], v1, s[12:15], s82 offen offset:256 nt
    buffer_load_dwordx4 v[204:207], v1, s[12:15], s82 offen offset:3072 nt
    buffer_load_dwordx4 v[208:211], v1, s[12:15], s82 offen offset:3200 nt
    buffer_load_dwordx4 v[212:215], v1, s[12:15], s82 offen offset:3328 nt
    buffer_load_dwordx4 v[216:219], v1, s[12:15], s83 offen offset:0 nt
    buffer_load_dwordx4 v[220:223], v1, s[12:15], s83 offen offset:128 nt
    buffer_load_dwordx4 v[224:227], v1, s[12:15], s83 offen offset:256 nt
    buffer_load_dwordx4 v[228:231], v1, s[12:15], s83 offen offset:3072 nt
    buffer_load_dwordx4 v[232:235], v1, s[12:15], s83 offen offset:3200 nt
    buffer_load_dwordx4 v[236:239], v1, s[12:15], s83 offen offset:3328 nt
    v_mfma_f32_16x16x32_bf16 v[8:11], v[88:91], v[20:23], v[8:11]
    v_mfma_f32_16x16x32_bf16 v[12:15], v[92:95], v[20:23], v[12:15]
    v_mfma_f32_16x16x32_bf16 v[16:19], v[96:99], v[20:23], v[16:19]
    v_mfma_f32_16x16x32_bf16 v[8:11], v[100:103], v[24:27], v[8:11]
    v_mfma_f32_16x16x32_bf16 v[12:15], v[104:107], v[24:27], v[12:15]
    v_mfma_f32_16x16x32_bf16 v[16:19], v[108:111], v[24:27], v[16:19]
    s_mov_b64 exec, 1
    ds_add_u32 v31, v33
    s_mov_b64 exec, -1
    s_waitcnt lgkmcnt(0)
    v_lshlrev_b32 v29, 16, v28
    v_and_b32 v30, 0xffff0000, v28
    v_sub_f32 v29, v29, v36
    v_sub_f32 v30, v30, v36
    v_mul_f32 v29, 0x3fb8aa3b, v29
    v_mul_f32 v30, 0x3fb8aa3b, v30
    v_exp_f32 v29, v29
    v_exp_f32 v30, v30
    v_mul_f32 v29, v29, v37
    v_mul_f32 v30, v30, v37
    v_cvt_pk_bf16_f32 v29, v29, v29
    v_cvt_pk_bf16_f32 v30, v30, v30
    v_and_b32 v20, v29, v4
    v_and_b32 v24, v30, v4
    v_and_b32 v21, v29, v5
    v_and_b32 v25, v30, v5
    v_and_b32 v22, v29, v6
    v_and_b32 v26, v30, v6
    v_and_b32 v23, v29, v7
    v_and_b32 v27, v30, v7
    ds_read_b32 v28, v2 offset:64
    v_mfma_f32_16x16x32_bf16 v[8:11], v[112:115], v[20:23], v[8:11]
    v_mfma_f32_16x16x32_bf16 v[12:15], v[116:119], v[20:23], v[12:15]
    v_mfma_f32_16x16x32_bf16 v[16:19], v[120:123], v[20:23], v[16:19]
    v_mfma_f32_16x16x32_bf16 v[8:11], v[124:127], v[24:27], v[8:11]
    v_mfma_f32_16x16x32_bf16 v[12:15], v[128:131], v[24:27], v[12:15]
    v_mfma_f32_16x16x32_bf16 v[16:19], v[132:135], v[24:27], v[16:19]
    s_mov_b64 exec, 1
    ds_add_u32 v31, v33
    s_mov_b64 exec, -1
    s_waitcnt lgkmcnt(0)
    v_lshlrev_b32 v29, 16, v28
    v_and_b32 v30, 0xffff0000, v28
    v_sub_f32 v29, v29, v36
    v_sub_f32 v30, v30, v36
    v_mul_f32 v29, 0x3fb8aa3b, v29
    v_mul_f32 v30, 0x3fb8aa3b, v30
    v_exp_f32 v29, v29
    v_exp_f32 v30, v30
    v_mul_f32 v29, v29, v37
    v_mul_f32 v30, v30, v37
    v_cvt_pk_bf16_f32 v29, v29, v29
    v_cvt_pk_bf16_f32 v30, v30, v30
    v_and_b32 v20, v29, v4
    v_and_b32 v24, v30, v4
    v_and_b32 v21, v29, v5
    v_and_b32 v25, v30, v5
    v_and_b32 v22, v29, v6
    v_and_b32 v26, v30, v6
    v_and_b32 v23, v29, v7
    v_and_b32 v27, v30, v7
    v_add_u32 v2, 64, v2
L_deep2:
    s_add_u32 s84, s84, 1
    s_add_u32 s82, s82, s88
    s_add_u32 s83, s82, 196608
    s_cmp_eq_u32 s84, 32
    ds_read_b32 v28, v2 offset:32
    s_waitcnt vmcnt(0)
    s_cbranch_scc1 L_deepz2
    buffer_load_dwordx4 v[88:91], v1, s[12:15], s82 offen offset:0 nt
    buffer_load_dwordx4 v[92:95], v1, s[12:15], s82 offen offset:128 nt
    buffer_load_dwordx4 v[96:99], v1, s[12:15], s82 offen offset:256 nt
    buffer_load_dwordx4 v[100:103], v1, s[12:15], s82 offen offset:3072 nt
    buffer_load_dwordx4 v[104:107], v1, s[12:15], s82 offen offset:3200 nt
    buffer_load_dwordx4 v[108:111], v1, s[12:15], s82 offen offset:3328 nt
    buffer_load_dwordx4 v[112:115], v1, s[12:15], s83 offen offset:0 nt
    buffer_load_dwordx4 v[116:119], v1, s[12:15], s83 offen offset:128 nt
    buffer_load_dwordx4 v[120:123], v1, s[12:15], s83 offen offset:256 nt
    buffer_load_dwordx4 v[124:127], v1, s[12:15], s83 offen offset:3072 nt
    buffer_load_dwordx4 v[128:131], v1, s[12:15], s83 offen offset:3200 nt
    buffer_load_dwordx4 v[132:135], v1, s[12:15], s83 offen offset:3328 nt
    v_mfma_f32_16x16x32_bf16 v[8:11], v[192:195], v[20:23], v[8:11]
    v_mfma_f32_16x16x32_bf16 v[12:15], v[196:199], v[20:23], v[12:15]
    v_mfma_f32_16x16x32_bf16 v[16:19], v[200:203], v[20:23], v[16:19]
    v_mfma_f32_16x16x32_bf16 v[8:11], v[204:207], v[24:27], v[8:11]
    v_mfma_f32_16x16x32_bf16 v[12:15], v[208:211], v[24:27], v[12:15]
    v_mfma_f32_16x16x32_bf16 v[16:19], v[212:215], v[24:27], v[16:19]
    s_mov_b64 exec, 1
    ds_add_u32 v31, v33
    s_mov_b64 exec, -1
    s_waitcnt lgkmcnt(0)
    v_lshlrev_b32 v29, 16, v28
    v_and_b32 v30, 0xffff0000, v28
    v_sub_f32 v29, v29, v36
    v_sub_f32 v30, v30, v36
    v_mul_f32 v29, 0x3fb8aa3b, v29
    v_mul_f32 v30, 0x3fb8aa3b, v30
    v_exp_f32 v29, v29
    v_exp_f32 v30, v30
    v_mul_f32 v29, v29, v37
    v_mul_f32 v30, v30, v37
    v_cvt_pk_bf16_f32 v29, v29, v29
    v_cvt_pk_bf16_f32 v30, v30, v30
    v_and_b32 v20, v29, v4
    v_and_b32 v24, v30, v4
    v_and_b32 v21, v29, v5
    v_and_b32 v25, v30, v5
    v_and_b32 v22, v29, v6
    v_and_b32 v26, v30, v6
    v_and_b32 v23, v29, v7
    v_and_b32 v27, v30, v7
    ds_read_b32 v28, v2 offset:64
    v_mfma_f32_16x16x32_bf16 v[8:11], v[216:219], v[20:23], v[8:11]
    v_mfma_f32_16x16x32_bf16 v[12:15], v[220:223], v[20:23], v[12:15]
    v_mfma_f32_16x16x32_bf16 v[16:19], v[224:227], v[20:23], v[16:19]
    v_mfma_f32_16x16x32_bf16 v[8:11], v[228:231], v[24:27], v[8:11]
    v_mfma_f32_16x16x32_bf16 v[12:15], v[232:235], v[24:27], v[12:15]
    v_mfma_f32_16x16x32_bf16 v[16:19], v[236:239], v[24:27], v[16:19]
    s_mov_b64 exec, 1
    ds_add_u32 v31, v33
    s_mov_b64 exec, -1
    s_waitcnt lgkmcnt(0)
    v_lshlrev_b32 v29, 16, v28
    v_and_b32 v30, 0xffff0000, v28
    v_sub_f32 v29, v29, v36
    v_sub_f32 v30, v30, v36
    v_mul_f32 v29, 0x3fb8aa3b, v29
    v_mul_f32 v30, 0x3fb8aa3b, v30
    v_exp_f32 v29, v29
    v_exp_f32 v30, v30
    v_mul_f32 v29, v29, v37
    v_mul_f32 v30, v30, v37
    v_cvt_pk_bf16_f32 v29, v29, v29
    v_cvt_pk_bf16_f32 v30, v30, v30
    v_and_b32 v20, v29, v4
    v_and_b32 v24, v30, v4
    v_and_b32 v21, v29, v5
    v_and_b32 v25, v30, v5
    v_and_b32 v22, v29, v6
    v_and_b32 v26, v30, v6
    v_and_b32 v23, v29, v7
    v_and_b32 v27, v30, v7
    v_add_u32 v2, 64, v2
    s_branch L_deep1
L_deepz2:
    v_mfma_f32_16x16x32_bf16 v[8:11], v[192:195], v[20:23], v[8:11]
    v_mfma_f32_16x16x32_bf16 v[12:15], v[196:199], v[20:23], v[12:15]
    v_mfma_f32_16x16x32_bf16 v[16:19], v[200:203], v[20:23], v[16:19]
    v_mfma_f32_16x16x32_bf16 v[8:11], v[204:207], v[24:27], v[8:11]
    v_mfma_f32_16x16x32_bf16 v[12:15], v[208:211], v[24:27], v[12:15]
    v_mfma_f32_16x16x32_bf16 v[16:19], v[212:215], v[24:27], v[16:19]
    s_mov_b64 exec, 1
    ds_add_u32 v31, v33
    s_mov_b64 exec, -1
    s_waitcnt lgkmcnt(0)
    v_lshlrev_b32 v29, 16, v28
    v_and_b32 v30, 0xffff0000, v28
    v_sub_f32 v29, v29, v36
    v_sub_f32 v30, v30, v36
    v_mul_f32 v29, 0x3fb8aa3b, v29
    v_mul_f32 v30, 0x3fb8aa3b, v30
    v_exp_f32 v29, v29
    v_exp_f32 v30, v30
    v_mul_f32 v29, v29, v37
    v_mul_f32 v30, v30, v37
    v_cvt_pk_bf16_f32 v29, v29, v29
    v_cvt_pk_bf16_f32 v30, v30, v30
    v_and_b32 v20, v29, v4
    v_and_b32 v24, v30, v4
    v_and_b32 v21, v29, v5
    v_and_b32 v25, v30, v5
    v_and_b32 v22, v29, v6
    v_and_b32 v26, v30, v6
    v_and_b32 v23, v29, v7
    v_and_b32 v27, v30, v7
    s_nop 0
    v_mfma_f32_16x16x32_bf16 v[8:11], v[216:219], v[20:23], v[8:11]
    v_mfma_f32_16x16x32_bf16 v[12:15], v[220:223], v[20:23], v[12:15]
    v_mfma_f32_16x16x32_bf16 v[16:19], v[224:227], v[20:23], v[16:19]
    v_mfma_f32_16x16x32_bf16 v[8:11], v[228:231], v[24:27], v[8:11]
    v_mfma_f32_16x16x32_bf16 v[12:15], v[232:235], v[24:27], v[12:15]
    v_mfma_f32_16x16x32_bf16 v[16:19], v[236:239], v[24:27], v[16:19]
    s_branch L_vfin
L_deepz1:
    v_mfma_f32_16x16x32_bf16 v[8:11], v[88:91], v[20:23], v[8:11]
    v_mfma_f32_16x16x32_bf16 v[12:15], v[92:95], v[20:23], v[12:15]
    v_mfma_f32_16x16x32_bf16 v[16:19], v[96:99], v[20:23], v[16:19]
    v_mfma_f32_16x16x32_bf16 v[8:11], v[100:103], v[24:27], v[8:11]
    v_mfma_f32_16x16x32_bf16 v[12:15], v[104:107], v[24:27], v[12:15]
    v_mfma_f32_16x16x32_bf16 v[16:19], v[108:111], v[24:27], v[16:19]
    s_mov_b64 exec, 1
    ds_add_u32 v31, v33
    s_mov_b64 exec, -1
    s_waitcnt lgkmcnt(0)
    v_lshlrev_b32 v29, 16, v28
    v_and_b32 v30, 0xffff0000, v28
    v_sub_f32 v29, v29, v36
    v_sub_f32 v30, v30, v36
    v_mul_f32 v29, 0x3fb8aa3b, v29
    v_mul_f32 v30, 0x3fb8aa3b, v30
    v_exp_f32 v29, v29
    v_exp_f32 v30, v30
    v_mul_f32 v29, v29, v37
    v_mul_f32 v30, v30, v37
    v_cvt_pk_bf16_f32 v29, v29, v29
    v_cvt_pk_bf16_f32 v30, v30, v30
    v_and_b32 v20, v29, v4
    v_and_b32 v24, v30, v4
    v_and_b32 v21, v29, v5
    v_and_b32 v25, v30, v5
    v_and_b32 v22, v29, v6
    v_and_b32 v26, v30, v6
    v_and_b32 v23, v29, v7
    v_and_b32 v27, v30, v7
    s_branch L_vfb
L_flush:
    s_mov_b32 exec_lo, 0xff00ff
    s_mov_b32 exec_hi, 0xff00ff00
    s_nop 1
    ds_write_b128 v3, v[8:11] offset:0
    ds_write_b128 v3, v[12:15] offset:256
    ds_write_b128 v3, v[16:19] offset:512
    s_mov_b64 exec, 1
    ds_add_rtn_u32 v28, v32, v33
    ds_add_u32 v31, v33
    s_mov_b64 exec, -1
    s_waitcnt lgkmcnt(0)
    v_mov_b32 v8, 0
    v_mov_b32 v9, 0
    v_mov_b32 v10, 0
    v_mov_b32 v11, 0
    v_mov_b32 v12, 0
    v_mov_b32 v13, 0
    v_mov_b32 v14, 0
    v_mov_b32 v15, 0
    v_mov_b32 v16, 0
    v_mov_b32 v17, 0
    v_mov_b32 v18, 0
    v_mov_b32 v19, 0
    v_add_u32 v3, 6144, v3
    v_add_u32 v32, 4, v32
    s_mov_b32 s94, 0x40000
L_stat_5:
    ds_read_b128 v[36:39], v35 offset:64
    s_waitcnt lgkmcnt(0)
    v_readfirstlane_b32 s93, v38
    s_cmp_lg_u32 s93, 0
    s_cbranch_scc1 L_stat_ok_6
    s_sleep 2
    s_sub_u32 s94, s94, 1
    s_cmp_lg_u32 s94, 0
    s_cbranch_scc1 L_stat_5
L_stat_ok_6:
    v_add_u32 v35, 16, v35
    ds_read_b32 v28, v2
    s_waitcnt lgkmcnt(0)
    v_lshlrev_b32 v29, 16, v28
    v_and_b32 v30, 0xffff0000, v28
    v_sub_f32 v29, v29, v36
    v_sub_f32 v30, v30, v36
    v_mul_f32 v29, 0x3fb8aa3b, v29
    v_mul_f32 v30, 0x3fb8aa3b, v30
    v_exp_f32 v29, v29
    v_exp_f32 v30, v30
    v_mul_f32 v29, v29, v37
    v_mul_f32 v30, v30, v37
    v_cvt_pk_bf16_f32 v29, v29, v29
    v_cvt_pk_bf16_f32 v30, v30, v30
    v_and_b32 v20, v29, v4
    v_and_b32 v24, v30, v4
    v_and_b32 v21, v29, v5
    v_and_b32 v25, v30, v5
    v_and_b32 v22, v29, v6
    v_and_b32 v26, v30, v6
    v_and_b32 v23, v29, v7
    v_and_b32 v27, v30, v7
    s_branch L_v
L_vfa:
    v_mfma_f32_16x16x32_bf16 v[8:11], v[88:91], v[20:23], v[8:11]
    v_mfma_f32_16x16x32_bf16 v[12:15], v[92:95], v[20:23], v[12:15]
    v_mfma_f32_16x16x32_bf16 v[16:19], v[96:99], v[20:23], v[16:19]
    v_mfma_f32_16x16x32_bf16 v[8:11], v[100:103], v[24:27], v[8:11]
    v_mfma_f32_16x16x32_bf16 v[12:15], v[104:107], v[24:27], v[12:15]
    v_mfma_f32_16x16x32_bf16 v[16:19], v[108:111], v[24:27], v[16:19]
    s_branch L_vfin
L_v_last:
    s_add_u32 s83, s82, 196608
    s_waitcnt vmcnt(0)
    buffer_load_dwordx4 v[88:91], v1, s[12:15], s82 offen offset:0 nt
    buffer_load_dwordx4 v[92:95], v1, s[12:15], s82 offen offset:128 nt
    buffer_load_dwordx4 v[96:99], v1, s[12:15], s82 offen offset:256 nt
    buffer_load_dwordx4 v[100:103], v1, s[12:15], s82 offen offset:3072 nt
    buffer_load_dwordx4 v[104:107], v1, s[12:15], s82 offen offset:3200 nt
    buffer_load_dwordx4 v[108:111], v1, s[12:15], s82 offen offset:3328 nt
    ds_read_b32 v28, v2 offset:0
    v_mfma_f32_16x16x32_bf16 v[8:11], v[112:115], v[20:23], v[8:11]
    v_mfma_f32_16x16x32_bf16 v[12:15], v[116:119], v[20:23], v[12:15]
    v_mfma_f32_16x16x32_bf16 v[16:19], v[120:123], v[20:23], v[16:19]
    v_mfma_f32_16x16x32_bf16 v[8:11], v[124:127], v[24:27], v[8:11]
    v_mfma_f32_16x16x32_bf16 v[12:15], v[128:131], v[24:27], v[12:15]
    v_mfma_f32_16x16x32_bf16 v[16:19], v[132:135], v[24:27], v[16:19]
    s_mov_b64 exec, 1
    ds_add_u32 v31, v33
    s_mov_b64 exec, -1
    s_waitcnt lgkmcnt(0)
    v_lshlrev_b32 v29, 16, v28
    v_and_b32 v30, 0xffff0000, v28
    v_sub_f32 v29, v29, v36
    v_sub_f32 v30, v30, v36
    v_mul_f32 v29, 0x3fb8aa3b, v29
    v_mul_f32 v30, 0x3fb8aa3b, v30
    v_exp_f32 v29, v29
    v_exp_f32 v30, v30
    v_mul_f32 v29, v29, v37
    v_mul_f32 v30, v30, v37
    v_cvt_pk_bf16_f32 v29, v29, v29
    v_cvt_pk_bf16_f32 v30, v30, v30
    v_and_b32 v20, v29, v4
    v_and_b32 v24, v30, v4
    v_and_b32 v21, v29, v5
    v_and_b32 v25, v30, v5
    v_and_b32 v22, v29, v6
    v_and_b32 v26, v30, v6
    v_and_b32 v23, v29, v7
    v_and_b32 v27, v30, v7
    s_cmp_eq_u32 s89, 1
    s_waitcnt vmcnt(0)
    s_cbranch_scc1 L_vfa
    buffer_load_dwordx4 v[112:115], v1, s[12:15], s83 offen offset:0 nt
    buffer_load_dwordx4 v[116:119], v1, s[12:15], s83 offen offset:128 nt
    buffer_load_dwordx4 v[120:123], v1, s[12:15], s83 offen offset:256 nt
    buffer_load_dwordx4 v[124:127], v1, s[12:15], s83 offen offset:3072 nt
    buffer_load_dwordx4 v[128:131], v1, s[12:15], s83 offen offset:3200 nt
    buffer_load_dwordx4 v[132:135], v1, s[12:15], s83 offen offset:3328 nt
    ds_read_b32 v28, v2 offset:32
    v_mfma_f32_16x16x32_bf16 v[8:11], v[88:91], v[20:23], v[8:11]
    v_mfma_f32_16x16x32_bf16 v[12:15], v[92:95], v[20:23], v[12:15]
    v_mfma_f32_16x16x32_bf16 v[16:19], v[96:99], v[20:23], v[16:19]
    v_mfma_f32_16x16x32_bf16 v[8:11], v[100:103], v[24:27], v[8:11]
    v_mfma_f32_16x16x32_bf16 v[12:15], v[104:107], v[24:27], v[12:15]
    v_mfma_f32_16x16x32_bf16 v[16:19], v[108:111], v[24:27], v[16:19]
    s_mov_b64 exec, 1
    ds_add_u32 v31, v33
    s_mov_b64 exec, -1
    s_waitcnt lgkmcnt(0)
    v_lshlrev_b32 v29, 16, v28
    v_and_b32 v30, 0xffff0000, v28
    v_sub_f32 v29, v29, v36
    v_sub_f32 v30, v30, v36
    v_mul_f32 v29, 0x3fb8aa3b, v29
    v_mul_f32 v30, 0x3fb8aa3b, v30
    v_exp_f32 v29, v29
    v_exp_f32 v30, v30
    v_mul_f32 v29, v29, v37
    v_mul_f32 v30, v30, v37
    v_cvt_pk_bf16_f32 v29, v29, v29
    v_cvt_pk_bf16_f32 v30, v30, v30
    v_and_b32 v20, v29, v4
    v_and_b32 v24, v30, v4
    v_and_b32 v21, v29, v5
    v_and_b32 v25, v30, v5
    v_and_b32 v22, v29, v6
    v_and_b32 v26, v30, v6
    v_and_b32 v23, v29, v7
    v_and_b32 v27, v30, v7
    s_cmp_eq_u32 s89, 2
    s_waitcnt vmcnt(0)
    s_cbranch_scc1 L_vfb
    buffer_load_dwordx4 v[88:91], v1, s[12:15], s90 offen offset:0 nt
    buffer_load_dwordx4 v[92:95], v1, s[12:15], s90 offen offset:128 nt
    buffer_load_dwordx4 v[96:99], v1, s[12:15], s90 offen offset:256 nt
    buffer_load_dwordx4 v[100:103], v1, s[12:15], s90 offen offset:3072 nt
    buffer_load_dwordx4 v[104:107], v1, s[12:15], s90 offen offset:3200 nt
    buffer_load_dwordx4 v[108:111], v1, s[12:15], s90 offen offset:3328 nt
    ds_read_b32 v28, v2 offset:64
    v_mfma_f32_16x16x32_bf16 v[8:11], v[112:115], v[20:23], v[8:11]
    v_mfma_f32_16x16x32_bf16 v[12:15], v[116:119], v[20:23], v[12:15]
    v_mfma_f32_16x16x32_bf16 v[16:19], v[120:123], v[20:23], v[16:19]
    v_mfma_f32_16x16x32_bf16 v[8:11], v[124:127], v[24:27], v[8:11]
    v_mfma_f32_16x16x32_bf16 v[12:15], v[128:131], v[24:27], v[12:15]
    v_mfma_f32_16x16x32_bf16 v[16:19], v[132:135], v[24:27], v[16:19]
    s_mov_b64 exec, 1
    ds_add_u32 v31, v33
    s_mov_b64 exec, -1
    s_waitcnt lgkmcnt(0)
    v_lshlrev_b32 v29, 16, v28
    v_and_b32 v30, 0xffff0000, v28
    v_sub_f32 v29, v29, v36
    v_sub_f32 v30, v30, v36
    v_mul_f32 v29, 0x3fb8aa3b, v29
    v_mul_f32 v30, 0x3fb8aa3b, v30
    v_exp_f32 v29, v29
    v_exp_f32 v30, v30
    v_mul_f32 v29, v29, v37
    v_mul_f32 v30, v30, v37
    v_cvt_pk_bf16_f32 v29, v29, v29
    v_cvt_pk_bf16_f32 v30, v30, v30
    v_and_b32 v20, v29, v4
    v_and_b32 v24, v30, v4
    v_and_b32 v21, v29, v5
    v_and_b32 v25, v30, v5
    v_and_b32 v22, v29, v6
    v_and_b32 v26, v30, v6
    v_and_b32 v23, v29, v7
    v_and_b32 v27, v30, v7
    s_waitcnt vmcnt(0)
    buffer_load_dwordx4 v[112:115], v1, s[12:15], s91 offen offset:0 nt
    buffer_load_dwordx4 v[116:119], v1, s[12:15], s91 offen offset:128 nt
    buffer_load_dwordx4 v[120:123], v1, s[12:15], s91 offen offset:256 nt
    buffer_load_dwordx4 v[124:127], v1, s[12:15], s91 offen offset:3072 nt
    buffer_load_dwordx4 v[128:131], v1, s[12:15], s91 offen offset:3200 nt
    buffer_load_dwordx4 v[132:135], v1, s[12:15], s91 offen offset:3328 nt
    ds_read_b32 v28, v2 offset:96
    v_mfma_f32_16x16x32_bf16 v[8:11], v[88:91], v[20:23], v[8:11]
    v_mfma_f32_16x16x32_bf16 v[12:15], v[92:95], v[20:23], v[12:15]
    v_mfma_f32_16x16x32_bf16 v[16:19], v[96:99], v[20:23], v[16:19]
    v_mfma_f32_16x16x32_bf16 v[8:11], v[100:103], v[24:27], v[8:11]
    v_mfma_f32_16x16x32_bf16 v[12:15], v[104:107], v[24:27], v[12:15]
    v_mfma_f32_16x16x32_bf16 v[16:19], v[108:111], v[24:27], v[16:19]
    s_mov_b64 exec, 1
    ds_add_u32 v31, v33
    s_mov_b64 exec, -1
    s_waitcnt lgkmcnt(0)
    v_lshlrev_b32 v29, 16, v28
    v_and_b32 v30, 0xffff0000, v28
    v_sub_f32 v29, v29, v36
    v_sub_f32 v30, v30, v36
    v_mul_f32 v29, 0x3fb8aa3b, v29
    v_mul_f32 v30, 0x3fb8aa3b, v30
    v_exp_f32 v29, v29
    v_exp_f32 v30, v30
    v_mul_f32 v29, v29, v37
    v_mul_f32 v30, v30, v37
    v_cvt_pk_bf16_f32 v29, v29, v29
    v_cvt_pk_bf16_f32 v30, v30, v30
    v_and_b32 v20, v29, v4
    v_and_b32 v24, v30, v4
    v_and_b32 v21, v29, v5
    v_and_b32 v25, v30, v5
    v_and_b32 v22, v29, v6
    v_and_b32 v26, v30, v6
    v_and_b32 v23, v29, v7
    v_and_b32 v27, v30, v7
    s_waitcnt vmcnt(0)
L_vfb:
    v_mfma_f32_16x16x32_bf16 v[8:11], v[112:115], v[20:23], v[8:11]
    v_mfma_f32_16x16x32_bf16 v[12:15], v[116:119], v[20:23], v[12:15]
    v_mfma_f32_16x16x32_bf16 v[16:19], v[120:123], v[20:23], v[16:19]
    v_mfma_f32_16x16x32_bf16 v[8:11], v[124:127], v[24:27], v[8:11]
    v_mfma_f32_16x16x32_bf16 v[12:15], v[128:131], v[24:27], v[12:15]
    v_mfma_f32_16x16x32_bf16 v[16:19], v[132:135], v[24:27], v[16:19]
L_vfin:
    s_mov_b32 exec_lo, 0xff00ff
    s_mov_b32 exec_hi, 0xff00ff00
    s_nop 3
    ds_write_b128 v3, v[8:11] offset:0
    ds_write_b128 v3, v[12:15] offset:256
    ds_write_b128 v3, v[16:19] offset:512
    s_mov_b64 exec, 1
    ds_add_rtn_u32 v28, v32, v33
    ds_add_u32 v31, v33
    s_mov_b32 exec_lo, 0xffffffff
    s_mov_b32 exec_hi, 0xffff
    ds_read_b128 v[160:163], v34 offset:28928
    ds_read_b128 v[164:167], v34 offset:29696
    ds_read_b128 v[168:171], v34 offset:30464
    ds_read_b128 v[172:175], v34 offset:31232
    ds_read_b128 v[176:179], v34 offset:32000
    ds_read_b128 v[180:183], v34 offset:32768
    ds_read_b128 v[184:187], v34 offset:33536
    ds_read_b128 v[188:191], v34 offset:34304
    s_waitcnt lgkmcnt(9)
    v_readfirstlane_b32 s87, v28
    s_cmp_lg_u32 s87, 3
    s_cbranch_scc1 L_notlast
    s_waitcnt lgkmcnt(6)
    v_pk_add_f32 v[160:161], v[160:161], v[164:165]
    v_pk_add_f32 v[162:163], v[162:163], v[166:167]
    s_waitcnt lgkmcnt(4)
    v_pk_add_f32 v[168:169], v[168:169], v[172:173]
    v_pk_add_f32 v[170:171], v[170:171], v[174:175]
    s_waitcnt lgkmcnt(2)
    v_pk_add_f32 v[176:177], v[176:177], v[180:181]
    v_pk_add_f32 v[178:179], v[178:179], v[182:183]
    s_waitcnt lgkmcnt(0)
    v_pk_add_f32 v[184:185], v[184:185], v[188:189]
    v_pk_add_f32 v[186:187], v[186:187], v[190:191]
    v_pk_add_f32 v[160:161], v[160:161], v[168:169]
    v_pk_add_f32 v[162:163], v[162:163], v[170:171]
    v_pk_add_f32 v[176:177], v[176:177], v[184:185]
    v_pk_add_f32 v[178:179], v[178:179], v[186:187]
    v_pk_add_f32 v[160:161], v[160:161], v[176:177]
    v_pk_add_f32 v[162:163], v[162:163], v[178:179]
    v_and_or_b32 v163, v163, s59, v140
    s_cmp_lg_u32 s64, 0
    s_cbranch_scc1 L_dev_7
    buffer_store_dwordx4 v[160:163], v34, s[16:19], s86 offen
L_devb_8:
    s_mov_b64 exec, -1
L_notlast:
    s_endpgm
L_helper:
    s_sub_u32 s82, s3, 4
    v_lshlrev_b32 v4, 2, v0
    v_mov_b32 v5, 0
    s_cmp_lg_u32 s82, 0
    s_cbranch_scc1 L_noinit
    ds_write_b32 v4, v5
L_noinit:
    v_and_b32 v1, 15, v0
    v_lshrrev_b32 v2, 4, v0
    s_lshr_b32 s89, s2, 5
    s_lshr_b32 s85, s5, 1
    s_and_b32 s6, s4, 3
    s_lshl_b32 s6, s6, 2
    s_add_u32 s6, s6, s85
    s_lshl_b32 s6, s6, 2
    s_mov_b32 s90, 0x32dc10ba
    s_mov_b32 s91, 0x987f654e
    s_lshr_b64 s[90:91], s[90:91], s6
    s_and_b32 s90, s90, 15
    s_mul_i32 s6, s89, 6
    s_add_u32 s6, s6, s90
    s_sub_u32 s91, s6, 10
    s_cmp_lt_u32 s90, 10
    s_cselect_b32 s88, 1, 2
    s_cmp_lt_u32 s85, 3
    s_cselect_b32 s7, 3, 0
    s_xor_b32 s6, s4, s5
    s_bitcmp1_b32 s6, 0
    s_cselect_b32 s88, s7, s88
    v_lshrrev_b32 v5, 2, v1
    v_mul_u32_u24 v5, 1280, v5
    v_and_b32 v6, 3, v1
    v_lshl_add_u32 v6, v2, 2, v6
    v_lshl_add_u32 v6, v6, 4, v5
    v_lshl_add_u32 v7, v2, 4, v5
    v_mul_u32_u24 v3, 98304, v2
    v_lshl_add_u32 v3, v1, 4, v3
    s_and_b32 s83, s2, 31
    s_mul_i32 s84, s83, 43
    s_lshr_b32 s84, s84, 8
    s_mul_i32 s6, s84, 6
    s_sub_u32 s12, s83, s6
    s_lshl_b32 s6, s84, 2
    s_add_u32 s6, s6, s82
    s_lshl_b32 s86, s6, 6
    s_mul_i32 s87, s6, 393216
    s_lshl_b32 s6, s12, 8
    s_add_u32 s87, s87, s6
    s_lshl_b32 s6, s12, 7
    v_lshl_add_u32 v8, v1, 3, s6
    v_mul_u32_u24 v8, 342, v8
    v_lshrrev_b32 v8, 16, v8
    v_mul_u32_u24 v5, 2688, v8
    v_add_u32 v3, v3, v5
    s_mul_i32 s6, s89, 384
    s_add_u32 s87, s87, s6
    v_and_b32 v5, 31, v0
    v_lshlrev_b32 v5, 2, v5
    s_lshl_b32 s6, s12, 7
    v_add_u32 v5, s6, v5
    v_mul_u32_u24 v8, 342, v5
    v_lshrrev_b32 v8, 16, v8
    v_lshlrev_b32 v5, 2, v5
    v_mul_u32_u24 v8, 14592, v8
    v_add_u32 v5, v5, v8
    v_lshrrev_b32 v8, 5, v0
    v_mul_u32_u24 v8, 768, v8
    v_add_u32 v5, v5, v8
    s_mul_i32 s6, s89, 20
    s_add_u32 s6, s6, s84
    s_mul_i32 s13, s6, 3072
    s_add_u32 s13, s13, 256
    s_cmp_lt_u32 s83, 30
    s_cselect_b32 s13, s13, 1956864
    s_mul_i32 s7, s82, 1536
    s_add_u32 s7, s7, s13
    s_cmp_lt_u32 s82, 2
    s_cselect_b32 s14, s7, 1956864
    s_waitcnt lgkmcnt(0)
    s_mov_b32 s20, s56
    s_and_b32 s21, s57, 0xffff
    s_mov_b32 s22, 5120
    s_mov_b32 s23, 0x20000
    s_mov_b32 s24, s62
    s_and_b32 s25, s63, 0xffff
    s_mov_b32 s26, 7864320
    s_mov_b32 s27, 0x20000
    s_load_dword s57, s[80:81], 0
    buffer_load_dwordx4 v[64:67], v6, s[20:23], 0 offen offset:0
    buffer_load_dwordx4 v[68:71], v6, s[20:23], 0 offen offset:256
    buffer_load_dwordx4 v[72:75], v6, s[20:23], 0 offen offset:512
    buffer_load_dwordx4 v[76:79], v6, s[20:23], 0 offen offset:768
    buffer_load_dwordx4 v[80:83], v6, s[20:23], 0 offen offset:1024
    buffer_load_dwordx4 v[84:87], v7, s[20:23], s86 offen
    s_mov_b32 s16, s80
    s_and_b32 s17, s81, 0xffff
    s_mov_b32 s18, 1956864
    s_mov_b32 s19, 0x20000
    buffer_load_dwordx4 v[88:91], v5, s[16:19], s14 offen sc1 nt
    buffer_load_dwordx4 v[128:131], v3, s[24:27], s87 offen nt
    s_add_u32 s87, s87, 12288
    buffer_load_dwordx4 v[132:135], v3, s[24:27], s87 offen nt
    s_add_u32 s87, s87, 12288
    buffer_load_dwordx4 v[136:139], v3, s[24:27], s87 offen nt
    s_add_u32 s87, s87, 12288
    buffer_load_dwordx4 v[140:143], v3, s[24:27], s87 offen nt
    s_add_u32 s87, s87, 12288
    buffer_load_dwordx4 v[144:147], v3, s[24:27], s87 offen nt
    s_add_u32 s87, s87, 12288
    buffer_load_dwordx4 v[148:151], v3, s[24:27], s87 offen nt
    s_add_u32 s87, s87, 12288
    buffer_load_dwordx4 v[152:155], v3, s[24:27], s87 offen nt
    s_add_u32 s87, s87, 12288
    buffer_load_dwordx4 v[156:159], v3, s[24:27], s87 offen nt
    s_barrier
    s_mov_b32 s52, s78
    s_and_b32 s53, s79, 0xffff
    s_mov_b32 s54, 256
    s_mov_b32 s55, 0x20000
    s_getreg_b32 s6, hwreg(HW_REG_XCC_ID, 0, 4)
    s_mul_i32 s7, s6, s6
    s_lshl_b32 s7, s7, 15
    s_lshl_b32 s6, s6, 6
    s_add_u32 s6, s6, s7
    s_add_u32 s15, s6, 1
    v_mov_b32 v33, 1
    v_mov_b32 v32, 0
    v_mov_b32 v34, s15
    s_lshl_b32 s14, s89, 5
    s_cmp_eq_u32 s82, 0
    s_cselect_b32 s7, s14, 256
    s_lshl_b32 s15, s15, 5
    s_mov_b64 exec, 1
    buffer_atomic_add v34, v32, s[52:55], s7 offen sc1
    s_mov_b64 exec, -1
    s_mov_b32 s28, s64
    s_and_b32 s29, s65, 0xffff
    s_mov_b32 s30, 7864320
    s_mov_b32 s31, 0x20000
    s_mov_b32 s32, s68
    s_and_b32 s33, s69, 0xffff
    s_mov_b32 s34, 1966080
    s_mov_b32 s35, 0x20000
    s_mov_b32 s36, s72
    s_and_b32 s37, s73, 0xffff
    s_mov_b32 s38, 1966080
    s_mov_b32 s39, 0x20000
    s_mov_b32 s40, s70
    s_and_b32 s41, s71, 0xffff
    s_mov_b32 s42, 3072
    s_mov_b32 s43, 0x20000
    s_mov_b32 s44, s74
    s_and_b32 s45, s75, 0xffff
    s_mov_b32 s46, 1280
    s_mov_b32 s47, 0x20000
    s_mov_b32 s48, s76
    s_and_b32 s49, s77, 0xffff
    s_mov_b32 s50, 5120
    s_mov_b32 s51, 0x20000
    s_mov_b32 s60, 0x05040100
    s_mov_b32 s61, 0x07060302
    s_mov_b32 s62, 0x3f803f80
    s_mov_b32 s64, 0
    s_lshl_b32 s6, s4, 2
    s_add_u32 s6, s6, s82
    s_lshl_b32 s9, s6, 7
    s_lshl_b32 s6, s6, 3
    s_add_u32 s6, s6, s5
    s_mul_i32 s8, s6, 768
    s_add_u32 s8, s8, 508160
    s_add_u32 s9, s9, 491776
    s_lshl_b32 s6, s5, 4
    s_add_u32 s10, s9, s6
    s_mul_i32 s6, s4, 20
    s_add_u32 s6, s6, s82
    s_mul_i32 s11, s6, 768
    s_add_u32 s11, s11, 256
    s_add_u32 s12, s11, 6144
    s_add_u32 s92, s11, 12288
    s_mov_b32 s56, 2
    s_lshl_b32 s56, s56, 2
    s_add_u32 s56, s56, 248
    v_lshlrev_b32 v4, 4, v0
    s_waitcnt lgkmcnt(0)
    s_mul_i32 s58, s57, 0x9e3779b1
    s_add_u32 s58, s58, 0x5bd1e995
    s_mov_b32 s59, 0xffffff00
    v_lshrrev_b32 v35, 1, v4
    v_and_b32 v35, 24, v35
    v_bfe_u32 v35, s58, v35, 8
    v_lshrrev_b32 v9, 1, v5
    v_and_b32 v9, 24, v9
    v_bfe_u32 v9, s58, v9, 8
    v_bfe_u32 v20, v9, 0, 2
    v_bfe_u32 v24, v35, 0, 2
    v_bfe_u32 v21, v9, 2, 2
    v_bfe_u32 v25, v35, 2, 2
    v_bfe_u32 v22, v9, 4, 2
    v_bfe_u32 v26, v35, 4, 2
    v_bfe_u32 v23, v9, 6, 2
    v_bfe_u32 v27, v35, 6, 2
    s_lshl_b32 s6, s82, 11
    s_add_u32 s6, s6, 10496
    v_lshl_add_u32 v8, v0, 5, s6
    s_waitcnt vmcnt(11)
    v_dot2_f32_bf16 v12, v64, s62, 0
    v_dot2_f32_bf16 v13, v64, v64, 0
    v_dot2_f32_bf16 v12, v65, s62, v12
    v_dot2_f32_bf16 v13, v65, v65, v13
    v_dot2_f32_bf16 v12, v66, s62, v12
    v_dot2_f32_bf16 v13, v66, v66, v13
    v_dot2_f32_bf16 v12, v67, s62, v12
    v_dot2_f32_bf16 v13, v67, v67, v13
    v_dot2_f32_bf16 v12, v68, s62, v12
    v_dot2_f32_bf16 v13, v68, v68, v13
    v_dot2_f32_bf16 v12, v69, s62, v12
    v_dot2_f32_bf16 v13, v69, v69, v13
    v_dot2_f32_bf16 v12, v70, s62, v12
    v_dot2_f32_bf16 v13, v70, v70, v13
    v_dot2_f32_bf16 v12, v71, s62, v12
    v_dot2_f32_bf16 v13, v71, v71, v13
    v_dot2_f32_bf16 v12, v72, s62, v12
    v_dot2_f32_bf16 v13, v72, v72, v13
    v_dot2_f32_bf16 v12, v73, s62, v12
    v_dot2_f32_bf16 v13, v73, v73, v13
    v_dot2_f32_bf16 v12, v74, s62, v12
    v_dot2_f32_bf16 v13, v74, v74, v13
    v_dot2_f32_bf16 v12, v75, s62, v12
    v_dot2_f32_bf16 v13, v75, v75, v13
    v_dot2_f32_bf16 v12, v76, s62, v12
    v_dot2_f32_bf16 v13, v76, v76, v13
    v_dot2_f32_bf16 v12, v77, s62, v12
    v_dot2_f32_bf16 v13, v77, v77, v13
    v_dot2_f32_bf16 v12, v78, s62, v12
    v_dot2_f32_bf16 v13, v78, v78, v13
    v_dot2_f32_bf16 v12, v79, s62, v12
    v_dot2_f32_bf16 v13, v79, v79, v13
    v_dot2_f32_bf16 v12, v80, s62, v12
    v_dot2_f32_bf16 v13, v80, v80, v13
    v_dot2_f32_bf16 v12, v81, s62, v12
    v_dot2_f32_bf16 v13, v81, v81, v13
    v_dot2_f32_bf16 v12, v82, s62, v12
    v_dot2_f32_bf16 v13, v82, v82, v13
    v_dot2_f32_bf16 v12, v83, s62, v12
    v_dot2_f32_bf16 v13, v83, v83, v13
    s_nop 1
    v_add_f32_dpp v12, v12, v12 quad_perm:[1,0,3,2] row_mask:0xf bank_mask:0xf
    v_add_f32_dpp v13, v13, v13 quad_perm:[1,0,3,2] row_mask:0xf bank_mask:0xf
    s_nop 0
    v_add_f32_dpp v12, v12, v12 quad_perm:[2,3,0,1] row_mask:0xf bank_mask:0xf
    v_add_f32_dpp v13, v13, v13 quad_perm:[2,3,0,1] row_mask:0xf bank_mask:0xf
    v_mov_b32 v14, v12
    v_mov_b32 v15, v13
    s_nop 0
    v_permlane16_swap_b32 v12, v14
    v_permlane16_swap_b32 v13, v15
    v_add_f32 v12, v12, v14
    v_add_f32 v13, v13, v15
    v_mov_b32 v14, v12
    v_mov_b32 v15, v13
    s_nop 0
    v_permlane32_swap_b32 v12, v14
    v_permlane32_swap_b32 v13, v15
    v_add_f32 v12, v12, v14
    v_add_f32 v13, v13, v15
    v_mul_f32 v12, 0x3acccccd, v12
    v_mul_f32 v13, 0x3acccccd, v13
    v_fma_f32 v13, -v12, v12, v13
    v_max_f32 v13, 0, v13
    v_cvt_pk_bf16_f32 v14, v12, v13
    v_lshlrev_b32 v12, 16, v14
    v_and_b32 v13, 0xffff0000, v14
    v_add_f32 v13, 0x3727c5ac, v13
    v_cvt_pk_bf16_f32 v13, v13, v13
    v_and_b32 v13, 0xffff0000, v13
    v_sqrt_f32 v13, v13
    s_nop 0
    v_cvt_pk_bf16_f32 v13, v13, v13
    v_and_b32 v13, 0xffff0000, v13
    v_rcp_f32 v13, v13
    s_waitcnt vmcnt(10)
    v_lshlrev_b32 v14, 16, v84
    v_and_b32 v15, 0xffff0000, v84
    v_lshlrev_b32 v16, 16, v85
    v_and_b32 v17, 0xffff0000, v85
    v_sub_f32 v14, v14, v12
    v_sub_f32 v15, v15, v12
    v_sub_f32 v16, v16, v12
    v_sub_f32 v17, v17, v12
    v_cvt_pk_bf16_f32 v84, v14, v15
    v_cvt_pk_bf16_f32 v85, v16, v17
    v_lshlrev_b32 v14, 16, v84
    v_and_b32 v15, 0xffff0000, v84
    v_lshlrev_b32 v16, 16, v85
    v_and_b32 v17, 0xffff0000, v85
    v_mul_f32 v14, v14, v13
    v_mul_f32 v15, v15, v13
    v_mul_f32 v16, v16, v13
    v_mul_f32 v17, v17, v13
    v_cvt_pk_bf16_f32 v84, v14, v15
    v_cvt_pk_bf16_f32 v85, v16, v17
    v_lshlrev_b32 v14, 16, v86
    v_and_b32 v15, 0xffff0000, v86
    v_lshlrev_b32 v16, 16, v87
    v_and_b32 v17, 0xffff0000, v87
    v_sub_f32 v14, v14, v12
    v_sub_f32 v15, v15, v12
    v_sub_f32 v16, v16, v12
    v_sub_f32 v17, v17, v12
    v_cvt_pk_bf16_f32 v86, v14, v15
    v_cvt_pk_bf16_f32 v87, v16, v17
    v_lshlrev_b32 v14, 16, v86
    v_and_b32 v15, 0xffff0000, v86
    v_lshlrev_b32 v16, 16, v87
    v_and_b32 v17, 0xffff0000, v87
    v_mul_f32 v14, v14, v13
    v_mul_f32 v15, v15, v13
    v_mul_f32 v16, v16, v13
    v_mul_f32 v17, v17, v13
    v_cvt_pk_bf16_f32 v86, v14, v15
    v_cvt_pk_bf16_f32 v87, v16, v17
    s_waitcnt vmcnt(7)
    v_perm_b32 v160, v132, v128, s60
    v_perm_b32 v164, v132, v128, s61
    v_perm_b32 v168, v133, v129, s60
    v_perm_b32 v172, v133, v129, s61
    v_perm_b32 v176, v134, v130, s60
    v_perm_b32 v180, v134, v130, s61
    v_perm_b32 v184, v135, v131, s60
    v_perm_b32 v188, v135, v131, s61
    s_waitcnt vmcnt(5)
    v_perm_b32 v161, v140, v136, s60
    v_perm_b32 v165, v140, v136, s61
    v_perm_b32 v169, v141, v137, s60
    v_perm_b32 v173, v141, v137, s61
    v_perm_b32 v177, v142, v138, s60
    v_perm_b32 v181, v142, v138, s61
    v_perm_b32 v185, v143, v139, s60
    v_perm_b32 v189, v143, v139, s61
    s_waitcnt vmcnt(3)
    v_perm_b32 v162, v148, v144, s60
    v_perm_b32 v166, v148, v144, s61
    v_perm_b32 v170, v149, v145, s60
    v_perm_b32 v174, v149, v145, s61
    v_perm_b32 v178, v150, v146, s60
    v_perm_b32 v182, v150, v146, s61
    v_perm_b32 v186, v151, v147, s60
    v_perm_b32 v190, v151, v147, s61
    s_waitcnt vmcnt(1)
    v_perm_b32 v163, v156, v152, s60
    v_perm_b32 v167, v156, v152, s61
    s_nop 0
    v_mfma_f32_16x16x32_bf16 v[96:99], v[84:87], v[160:163], 0
    v_perm_b32 v171, v157, v153, s60
    v_mfma_f32_16x16x32_bf16 v[100:103], v[84:87], v[164:167], 0
    v_perm_b32 v175, v157, v153, s61
    v_mfma_f32_16x16x32_bf16 v[104:107], v[84:87], v[168:171], 0
    v_perm_b32 v179, v158, v154, s60
    v_mfma_f32_16x16x32_bf16 v[108:111], v[84:87], v[172:175], 0
    v_perm_b32 v183, v158, v154, s61
    v_mfma_f32_16x16x32_bf16 v[112:115], v[84:87], v[176:179], 0
    v_perm_b32 v187, v159, v155, s60
    v_mfma_f32_16x16x32_bf16 v[116:119], v[84:87], v[180:183], 0
    v_perm_b32 v191, v159, v155, s61
    v_mfma_f32_16x16x32_bf16 v[120:123], v[84:87], v[184:187], 0
    s_nop 0
    v_mfma_f32_16x16x32_bf16 v[124:127], v[84:87], v[188:191], 0
    v_mov_b32 v97, v100
    v_mov_b32 v98, v104
    v_mov_b32 v99, v108
    ds_write_b128 v8, v[96:99]
    v_mov_b32 v113, v116
    s_nop 0
    v_mov_b32 v114, v120
    s_nop 0
    v_mov_b32 v115, v124
    ds_write_b128 v8, v[112:115] offset:16
    s_mov_b64 exec, 1
    ds_add_rtn_u32 v12, v32, v33 offset:0
    s_mov_b64 exec, -1
    ds_read_b128 v[128:131], v4 offset:10496
    ds_read_b128 v[132:135], v4 offset:12544
    ds_read_b128 v[136:139], v4 offset:14592
    ds_read_b128 v[140:143], v4 offset:16640
    ds_read_b128 v[144:147], v4 offset:11520
    ds_read_b128 v[148:151], v4 offset:13568
    ds_read_b128 v[152:155], v4 offset:15616
    ds_read_b128 v[156:159], v4 offset:17664
    s_waitcnt lgkmcnt(8)
    v_readfirstlane_b32 s63, v12
    s_cmp_lg_u32 s63, 3
    s_cbranch_scc1 L_qpub
    s_waitcnt lgkmcnt(6)
    v_pk_add_f32 v[128:129], v[128:129], v[132:133]
    v_pk_add_f32 v[130:131], v[130:131], v[134:135]
    s_waitcnt lgkmcnt(4)
    v_pk_add_f32 v[136:137], v[136:137], v[140:141]
    v_pk_add_f32 v[138:139], v[138:139], v[142:143]
    v_pk_add_f32 v[128:129], v[128:129], v[136:137]
    v_pk_add_f32 v[130:131], v[130:131], v[138:139]
    v_and_or_b32 v128, v128, -4, v20
    v_and_or_b32 v129, v129, -4, v21
    v_and_or_b32 v130, v130, -4, v22
    v_and_or_b32 v131, v131, -4, v23
    buffer_store_dwordx4 v[128:131], v5, s[16:19], s13 offen offset:0
    s_waitcnt lgkmcnt(2)
    v_pk_add_f32 v[144:145], v[144:145], v[148:149]
    v_pk_add_f32 v[146:147], v[146:147], v[150:151]
    s_waitcnt lgkmcnt(0)
    v_pk_add_f32 v[152:153], v[152:153], v[156:157]
    v_pk_add_f32 v[154:155], v[154:155], v[158:159]
    v_pk_add_f32 v[144:145], v[144:145], v[152:153]
    v_pk_add_f32 v[146:147], v[146:147], v[154:155]
    v_and_or_b32 v144, v144, -4, v20
    v_and_or_b32 v145, v145, -4, v21
    v_and_or_b32 v146, v146, -4, v22
    v_and_or_b32 v147, v147, -4, v23
    buffer_store_dwordx4 v[144:147], v5, s[16:19], s13 offen offset:1536
L_qpub:
    s_mul_i32 s6, s82, 384
    s_add_u32 s6, s6, 256
    v_lshl_add_u32 v10, v0, 3, s6
    s_sleep 16
    s_mov_b32 s67, 31
    s_mov_b32 s94, 0x8000
    s_mov_b32 exec_lo, 0xffffffff
    s_mov_b32 exec_hi, 0xffff
L_qg_poll_9:
    s_bitcmp1_b32 s67, 0
    s_cselect_b32 s68, -1, 0
    s_cbranch_scc0 L_qg_sk_11
    buffer_load_dwordx4 v[64:67], v4, s[16:19], s11 offen offset:0 sc1
L_qg_sk_11:
    s_bitcmp1_b32 s67, 1
    s_cselect_b32 s69, -1, 0
    s_cbranch_scc0 L_qg_sk_12
    buffer_load_dwordx4 v[68:71], v4, s[16:19], s11 offen offset:3072 sc1
L_qg_sk_12:
    s_bitcmp1_b32 s67, 2
    s_cselect_b32 s77, -1, 0
    s_cbranch_scc0 L_qg_sk_13
    buffer_load_dwordx4 v[72:75], v4, s[16:19], s12 offen offset:0 sc1
L_qg_sk_13:
    s_bitcmp1_b32 s67, 3
    s_cselect_b32 s83, -1, 0
    s_cbranch_scc0 L_qg_sk_14
    buffer_load_dwordx4 v[76:79], v4, s[16:19], s12 offen offset:3072 sc1
L_qg_sk_14:
    s_bitcmp1_b32 s67, 4
    s_cselect_b32 s84, -1, 0
    s_cbranch_scc0 L_qg_sk_15
    buffer_load_dwordx4 v[80:83], v4, s[16:19], s92 offen offset:0 sc1
L_qg_sk_15:
    s_waitcnt vmcnt(0)
    v_bitop3_b32 v64, v64, v24, s68 bitop3:0x78
    v_bitop3_b32 v65, v65, v25, s68 bitop3:0x78
    v_bitop3_b32 v66, v66, v26, s68 bitop3:0x78
    v_bitop3_b32 v67, v67, v27, s68 bitop3:0x78
    v_or3_b32 v14, v64, v65, v66
    v_bitop3_b32 v14, v14, v67, 3 bitop3:0xa8
    v_bitop3_b32 v68, v68, v24, s69 bitop3:0x78
    v_bitop3_b32 v69, v69, v25, s69 bitop3:0x78
    v_bitop3_b32 v70, v70, v26, s69 bitop3:0x78
    v_bitop3_b32 v71, v71, v27, s69 bitop3:0x78
    v_or3_b32 v15, v68, v69, v70
    v_bitop3_b32 v15, v15, v71, 3 bitop3:0xa8
    v_bitop3_b32 v72, v72, v24, s77 bitop3:0x78
    v_bitop3_b32 v73, v73, v25, s77 bitop3:0x78
    v_bitop3_b32 v74, v74, v26, s77 bitop3:0x78
    v_bitop3_b32 v75, v75, v27, s77 bitop3:0x78
    v_or3_b32 v16, v72, v73, v74
    v_bitop3_b32 v16, v16, v75, 3 bitop3:0xa8
    v_bitop3_b32 v76, v76, v24, s83 bitop3:0x78
    v_bitop3_b32 v77, v77, v25, s83 bitop3:0x78
    v_bitop3_b32 v78, v78, v26, s83 bitop3:0x78
    v_bitop3_b32 v79, v79, v27, s83 bitop3:0x78
    v_or3_b32 v17, v76, v77, v78
    v_bitop3_b32 v17, v17, v79, 3 bitop3:0xa8
    v_bitop3_b32 v80, v80, v24, s84 bitop3:0x78
    v_bitop3_b32 v81, v81, v25, s84 bitop3:0x78
    v_bitop3_b32 v82, v82, v26, s84 bitop3:0x78
    v_bitop3_b32 v83, v83, v27, s84 bitop3:0x78
    v_or3_b32 v18, v80, v81, v82
    v_bitop3_b32 v18, v18, v83, 3 bitop3:0xa8
    v_or3_b32 v13, v14, v15, v16
    v_or3_b32 v13, v13, v17, v18
    v_cmp_ne_u32_sdwa vcc, v13, v32 src0_sel:BYTE_0 src1_sel:DWORD
    s_cbranch_vccz L_qg_ok_10
    s_mov_b32 s67, 0
    v_cmp_ne_u32_sdwa vcc, v14, v32 src0_sel:BYTE_0 src1_sel:DWORD
    s_cmp_lg_u64 vcc, 0
    s_cselect_b32 s6, 1, 0
    s_or_b32 s67, s67, s6
    v_cmp_ne_u32_sdwa vcc, v15, v32 src0_sel:BYTE_0 src1_sel:DWORD
    s_cmp_lg_u64 vcc, 0
    s_cselect_b32 s6, 2, 0
    s_or_b32 s67, s67, s6
    v_cmp_ne_u32_sdwa vcc, v16, v32 src0_sel:BYTE_0 src1_sel:DWORD
    s_cmp_lg_u64 vcc, 0
    s_cselect_b32 s6, 4, 0
    s_or_b32 s67, s67, s6
    v_cmp_ne_u32_sdwa vcc, v17, v32 src0_sel:BYTE_0 src1_sel:DWORD
    s_cmp_lg_u64 vcc, 0
    s_cselect_b32 s6, 8, 0
    s_or_b32 s67, s67, s6
    v_cmp_ne_u32_sdwa vcc, v18, v32 src0_sel:BYTE_0 src1_sel:DWORD
    s_cmp_lg_u64 vcc, 0
    s_cselect_b32 s6, 16, 0
    s_or_b32 s67, s67, s6
    s_sleep 2
    s_cmp_lg_u32 s63, 3
    s_cbranch_scc1 L_qf_cont_16
    s_and_b32 s6, s94, 7
    s_cmp_lg_u32 s6, 1
    s_cbranch_scc1 L_qf_cont_16
    buffer_load_dword v12, v32, s[52:55], s14 offen sc1
    s_waitcnt vmcnt(0)
    v_readfirstlane_b32 s6, v12
    s_and_b32 s7, s6, 63
    s_cmp_lg_u32 s7, 32
    s_cbranch_scc1 L_qf_cont_16
    s_cmp_eq_u32 s6, s15
    s_cbranch_scc1 L_pure_17
    s_mov_b32 s64, 1
    s_mov_b64 exec, -1
    buffer_store_dwordx4 v[128:131], v5, s[16:19], s13 offen offset:0 sc1
    buffer_store_dwordx4 v[144:147], v5, s[16:19], s13 offen offset:1536 sc1
    s_mov_b32 exec_lo, 0xffffffff
    s_mov_b32 exec_hi, 0xffff
L_pure_17:
    s_add_u32 s6, s64, 1
    v_mov_b32 v12, s6
    s_mov_b32 s63, 4
    ds_write_b32 v32, v12 offset:136
L_qf_cont_16:
    s_sub_u32 s94, s94, 1
    s_cmp_lg_u32 s94, 0
    s_cbranch_scc1 L_qg_poll_9
L_qg_ok_10:
    v_pk_add_f32 v[64:65], v[64:65], v[68:69]
    v_pk_add_f32 v[66:67], v[66:67], v[70:71]
    v_pk_add_f32 v[72:73], v[72:73], v[76:77]
    v_pk_add_f32 v[74:75], v[74:75], v[78:79]
    v_pk_add_f32 v[64:65], v[64:65], v[72:73]
    v_pk_add_f32 v[66:67], v[66:67], v[74:75]
    v_pk_add_f32 v[64:65], v[64:65], v[80:81]
    v_pk_add_f32 v[66:67], v[66:67], v[82:83]
    v_cvt_pk_bf16_f32 v12, v64, v65
    v_cvt_pk_bf16_f32 v13, v66, v67
    ds_write_b64 v10, v[12:13]
    s_mov_b64 exec, 1
    ds_add_u32 v32, v33 offset:132
    s_mov_b64 exec, -1
    s_cmp_lg_u32 s63, 3
    s_cbranch_scc1 L_qdone
    s_mov_b32 s94, 0x800
L_cen:
    buffer_load_dword v12, v32, s[52:55], s14 offen sc1
    s_waitcnt vmcnt(0)
    v_readfirstlane_b32 s6, v12
    s_and_b32 s7, s6, 63
    s_cmp_lg_u32 s7, 32
    s_cbranch_scc1 L_cen_again
    s_cmp_eq_u32 s6, s15
    s_cbranch_scc1 L_pure_18
    s_mov_b32 s64, 1
    s_mov_b64 exec, -1
    buffer_store_dwordx4 v[128:131], v5, s[16:19], s13 offen offset:0 sc1
    buffer_store_dwordx4 v[144:147], v5, s[16:19], s13 offen offset:1536 sc1
    s_mov_b64 exec, -1
L_pure_18:
    s_add_u32 s6, s64, 1
    v_mov_b32 v12, s6
    s_mov_b32 s63, 4
    ds_write_b32 v32, v12 offset:136
    s_branch L_qdone
L_cen_again:
    s_sleep 32
    s_sub_u32 s94, s94, 1
    s_cmp_lg_u32 s94, 0
    s_cbranch_scc1 L_cen
    s_mov_b32 s6, 0
    s_cmp_eq_u32 s6, s15
    s_cbranch_scc1 L_pure_19
    s_mov_b32 s64, 1
    s_mov_b64 exec, -1
    buffer_store_dwordx4 v[128:131], v5, s[16:19], s13 offen offset:0 sc1
    buffer_store_dwordx4 v[144:147], v5, s[16:19], s13 offen offset:1536 sc1
    s_mov_b64 exec, -1
L_pure_19:
    s_add_u32 s6, s64, 1
    v_mov_b32 v12, s6
    s_mov_b32 s63, 4
    ds_write_b32 v32, v12 offset:136
L_qdone:
    s_waitcnt vmcnt(0) lgkmcnt(0)
    s_cmp_lg_u32 s88, 1
    s_cbranch_scc1 L_stats
    v_mul_u32_u24 v3, 2560, v2
    v_lshl_add_u32 v3, v1, 3, v3
    s_lshl_b32 s6, s89, 2
    s_add_u32 s92, s6, s82
    s_and_b32 s7, s92, 3
    s_lshr_b32 s6, s92, 2
    s_lshl3_add_u32 s7, s7, s6
    s_mul_i32 s7, s7, 245760
    s_lshl_b32 s6, s90, 7
    s_add_u32 s7, s7, s6
    buffer_load_dwordx2 v[160:161], v3, s[28:31], s7 offen offset:0 nt
    s_waitcnt vmcnt(0)
    buffer_load_dwordx2 v[168:169], v3, s[28:31], s7 offen offset:1280 nt
    s_add_u32 s7, s7, 10240
    s_waitcnt vmcnt(0)
    buffer_load_dwordx2 v[162:163], v3, s[28:31], s7 offen offset:0 nt
    s_waitcnt vmcnt(0)
    buffer_load_dwordx2 v[170:171], v3, s[28:31], s7 offen offset:1280 nt
    s_add_u32 s7, s7, 10240
    s_waitcnt vmcnt(0)
    buffer_load_dwordx2 v[164:165], v3, s[28:31], s7 offen offset:0 nt
    s_waitcnt vmcnt(0)
    buffer_load_dwordx2 v[172:173], v3, s[28:31], s7 offen offset:1280 nt
    s_add_u32 s7, s7, 10240
    s_waitcnt vmcnt(0)
    buffer_load_dwordx2 v[166:167], v3, s[28:31], s7 offen offset:0 nt
    s_waitcnt vmcnt(0)
    buffer_load_dwordx2 v[174:175], v3, s[28:31], s7 offen offset:1280 nt
    s_add_u32 s7, s7, 10240
    s_waitcnt vmcnt(0)
    buffer_load_dwordx2 v[176:177], v3, s[28:31], s7 offen offset:0 nt
    s_waitcnt vmcnt(0)
    buffer_load_dwordx2 v[184:185], v3, s[28:31], s7 offen offset:1280 nt
    s_add_u32 s7, s7, 10240
    s_waitcnt vmcnt(0)
    buffer_load_dwordx2 v[178:179], v3, s[28:31], s7 offen offset:0 nt
    s_waitcnt vmcnt(0)
    buffer_load_dwordx2 v[186:187], v3, s[28:31], s7 offen offset:1280 nt
    s_add_u32 s7, s7, 10240
    s_waitcnt vmcnt(0)
    buffer_load_dwordx2 v[180:181], v3, s[28:31], s7 offen offset:0 nt
    s_waitcnt vmcnt(0)
    buffer_load_dwordx2 v[188:189], v3, s[28:31], s7 offen offset:1280 nt
    s_add_u32 s7, s7, 10240
    s_waitcnt vmcnt(0)
    buffer_load_dwordx2 v[182:183], v3, s[28:31], s7 offen offset:0 nt
    s_waitcnt vmcnt(0)
    buffer_load_dwordx2 v[190:191], v3, s[28:31], s7 offen offset:1280 nt
    s_add_u32 s7, s7, 10240
    s_waitcnt vmcnt(0)
    buffer_load_dwordx2 v[192:193], v3, s[28:31], s7 offen offset:0 nt
    s_waitcnt vmcnt(0)
    buffer_load_dwordx2 v[200:201], v3, s[28:31], s7 offen offset:1280 nt
    s_add_u32 s7, s7, 10240
    s_waitcnt vmcnt(0)
    buffer_load_dwordx2 v[194:195], v3, s[28:31], s7 offen offset:0 nt
    s_waitcnt vmcnt(0)
    buffer_load_dwordx2 v[202:203], v3, s[28:31], s7 offen offset:1280 nt
    s_add_u32 s7, s7, 10240
    s_waitcnt vmcnt(0)
    buffer_load_dwordx2 v[196:197], v3, s[28:31], s7 offen offset:0 nt
    s_waitcnt vmcnt(0)
    buffer_load_dwordx2 v[204:205], v3, s[28:31], s7 offen offset:1280 nt
    s_add_u32 s7, s7, 10240
    s_waitcnt vmcnt(0)
    buffer_load_dwordx2 v[198:199], v3, s[28:31], s7 offen offset:0 nt
    s_waitcnt vmcnt(0)
    buffer_load_dwordx2 v[206:207], v3, s[28:31], s7 offen offset:1280 nt
    s_add_u32 s7, s7, 10240
    s_waitcnt vmcnt(0)
    buffer_load_dwordx2 v[208:209], v3, s[28:31], s7 offen offset:0 nt
    s_waitcnt vmcnt(0)
    buffer_load_dwordx2 v[216:217], v3, s[28:31], s7 offen offset:1280 nt
    s_add_u32 s7, s7, 10240
    s_waitcnt vmcnt(0)
    buffer_load_dwordx2 v[210:211], v3, s[28:31], s7 offen offset:0 nt
    s_waitcnt vmcnt(0)
    buffer_load_dwordx2 v[218:219], v3, s[28:31], s7 offen offset:1280 nt
    s_add_u32 s7, s7, 10240
    s_waitcnt vmcnt(0)
    buffer_load_dwordx2 v[212:213], v3, s[28:31], s7 offen offset:0 nt
    s_waitcnt vmcnt(0)
    buffer_load_dwordx2 v[220:221], v3, s[28:31], s7 offen offset:1280 nt
    s_add_u32 s7, s7, 10240
    s_waitcnt vmcnt(0)
    buffer_load_dwordx2 v[214:215], v3, s[28:31], s7 offen offset:0 nt
    s_waitcnt vmcnt(0)
    buffer_load_dwordx2 v[222:223], v3, s[28:31], s7 offen offset:1280 nt
    s_add_u32 s7, s7, 10240
    s_waitcnt vmcnt(0)
    buffer_load_dwordx2 v[224:225], v3, s[28:31], s7 offen offset:0 nt
    s_waitcnt vmcnt(0)
    buffer_load_dwordx2 v[232:233], v3, s[28:31], s7 offen offset:1280 nt
    s_add_u32 s7, s7, 10240
    s_waitcnt vmcnt(0)
    buffer_load_dwordx2 v[226:227], v3, s[28:31], s7 offen offset:0 nt
    s_waitcnt vmcnt(0)
    buffer_load_dwordx2 v[234:235], v3, s[28:31], s7 offen offset:1280 nt
    s_add_u32 s7, s7, 10240
    s_waitcnt vmcnt(0)
    buffer_load_dwordx2 v[228:229], v3, s[28:31], s7 offen offset:0 nt
    s_waitcnt vmcnt(0)
    buffer_load_dwordx2 v[236:237], v3, s[28:31], s7 offen offset:1280 nt
    s_add_u32 s7, s7, 10240
    s_waitcnt vmcnt(0)
    buffer_load_dwordx2 v[230:231], v3, s[28:31], s7 offen offset:0 nt
    s_waitcnt vmcnt(0)
    buffer_load_dwordx2 v[238:239], v3, s[28:31], s7 offen offset:1280 nt
    s_add_u32 s7, s7, 10240
    s_waitcnt vmcnt(0)
    buffer_load_dwordx2 v[240:241], v3, s[28:31], s7 offen offset:0 nt
    s_waitcnt vmcnt(0)
    buffer_load_dwordx2 v[248:249], v3, s[28:31], s7 offen offset:1280 nt
    s_add_u32 s7, s7, 10240
    s_waitcnt vmcnt(0)
    buffer_load_dwordx2 v[242:243], v3, s[28:31], s7 offen offset:0 nt
    s_waitcnt vmcnt(0)
    buffer_load_dwordx2 v[250:251], v3, s[28:31], s7 offen offset:1280 nt
    s_add_u32 s7, s7, 10240
    s_waitcnt vmcnt(0)
    buffer_load_dwordx2 v[244:245], v3, s[28:31], s7 offen offset:0 nt
    s_waitcnt vmcnt(0)
    buffer_load_dwordx2 v[252:253], v3, s[28:31], s7 offen offset:1280 nt
    s_add_u32 s7, s7, 10240
    s_waitcnt vmcnt(0)
    buffer_load_dwordx2 v[246:247], v3, s[28:31], s7 offen offset:0 nt
    s_waitcnt vmcnt(0)
    buffer_load_dwordx2 v[254:255], v3, s[28:31], s7 offen offset:1280 nt
    s_waitcnt vmcnt(0)
    s_waitcnt vmcnt(40)
    v_perm_b32 v64, v162, v160, s60
    v_perm_b32 v68, v162, v160, s61
    v_perm_b32 v65, v166, v164, s60
    v_perm_b32 v69, v166, v164, s61
    v_perm_b32 v66, v170, v168, s60
    v_perm_b32 v70, v170, v168, s61
    v_perm_b32 v67, v174, v172, s60
    v_perm_b32 v71, v174, v172, s61
    v_perm_b32 v72, v163, v161, s60
    v_perm_b32 v76, v163, v161, s61
    v_perm_b32 v73, v167, v165, s60
    v_perm_b32 v77, v167, v165, s61
    v_perm_b32 v74, v171, v169, s60
    v_perm_b32 v78, v171, v169, s61
    v_perm_b32 v75, v175, v173, s60
    v_perm_b32 v79, v175, v173, s61
    s_waitcnt vmcnt(32)
    v_perm_b32 v80, v178, v176, s60
    v_perm_b32 v84, v178, v176, s61
    v_perm_b32 v81, v182, v180, s60
    v_perm_b32 v85, v182, v180, s61
    v_perm_b32 v82, v186, v184, s60
    v_perm_b32 v86, v186, v184, s61
    v_perm_b32 v83, v190, v188, s60
    v_perm_b32 v87, v190, v188, s61
    v_perm_b32 v88, v179, v177, s60
    v_perm_b32 v92, v179, v177, s61
    v_perm_b32 v89, v183, v181, s60
    v_perm_b32 v93, v183, v181, s61
    v_perm_b32 v90, v187, v185, s60
    v_perm_b32 v94, v187, v185, s61
    v_perm_b32 v91, v191, v189, s60
    v_perm_b32 v95, v191, v189, s61
    s_waitcnt vmcnt(24)
    v_perm_b32 v96, v194, v192, s60
    v_perm_b32 v100, v194, v192, s61
    v_perm_b32 v97, v198, v196, s60
    v_perm_b32 v101, v198, v196, s61
    v_perm_b32 v98, v202, v200, s60
    v_perm_b32 v102, v202, v200, s61
    v_perm_b32 v99, v206, v204, s60
    v_perm_b32 v103, v206, v204, s61
    v_perm_b32 v104, v195, v193, s60
    v_perm_b32 v108, v195, v193, s61
    v_perm_b32 v105, v199, v197, s60
    v_perm_b32 v109, v199, v197, s61
    v_perm_b32 v106, v203, v201, s60
    v_perm_b32 v110, v203, v201, s61
    v_perm_b32 v107, v207, v205, s60
    v_perm_b32 v111, v207, v205, s61
    s_waitcnt vmcnt(16)
    v_perm_b32 v112, v210, v208, s60
    v_perm_b32 v116, v210, v208, s61
    v_perm_b32 v113, v214, v212, s60
    v_perm_b32 v117, v214, v212, s61
    v_perm_b32 v114, v218, v216, s60
    v_perm_b32 v118, v218, v216, s61
    v_perm_b32 v115, v222, v220, s60
    v_perm_b32 v119, v222, v220, s61
    v_perm_b32 v120, v211, v209, s60
    v_perm_b32 v124, v211, v209, s61
    v_perm_b32 v121, v215, v213, s60
    v_perm_b32 v125, v215, v213, s61
    v_perm_b32 v122, v219, v217, s60
    v_perm_b32 v126, v219, v217, s61
    v_perm_b32 v123, v223, v221, s60
    v_perm_b32 v127, v223, v221, s61
    s_waitcnt vmcnt(8)
    v_perm_b32 v128, v226, v224, s60
    v_perm_b32 v132, v226, v224, s61
    v_perm_b32 v129, v230, v228, s60
    v_perm_b32 v133, v230, v228, s61
    v_perm_b32 v130, v234, v232, s60
    v_perm_b32 v134, v234, v232, s61
    v_perm_b32 v131, v238, v236, s60
    v_perm_b32 v135, v238, v236, s61
    v_perm_b32 v136, v227, v225, s60
    v_perm_b32 v140, v227, v225, s61
    v_perm_b32 v137, v231, v229, s60
    v_perm_b32 v141, v231, v229, s61
    v_perm_b32 v138, v235, v233, s60
    v_perm_b32 v142, v235, v233, s61
    v_perm_b32 v139, v239, v237, s60
    v_perm_b32 v143, v239, v237, s61
    s_waitcnt vmcnt(0)
    v_perm_b32 v144, v242, v240, s60
    v_perm_b32 v148, v242, v240, s61
    v_perm_b32 v145, v246, v244, s60
    v_perm_b32 v149, v246, v244, s61
    v_perm_b32 v146, v250, v248, s60
    v_perm_b32 v150, v250, v248, s61
    v_perm_b32 v147, v254, v252, s60
    v_perm_b32 v151, v254, v252, s61
    v_perm_b32 v152, v243, v241, s60
    v_perm_b32 v156, v243, v241, s61
    v_perm_b32 v153, v247, v245, s60
    v_perm_b32 v157, v247, v245, s61
    v_perm_b32 v154, v251, v249, s60
    v_perm_b32 v158, v251, v249, s61
    v_perm_b32 v155, v255, v253, s60
    v_perm_b32 v159, v255, v253, s61
    s_branch L_stats
L_stats:
    s_mov_b32 s94, 0x40000
L_mode_20:
    ds_read_b32 v12, v32 offset:136
    s_waitcnt lgkmcnt(0)
    v_readfirstlane_b32 s93, v12
    s_cmp_lg_u32 s93, 0
    s_cbranch_scc1 L_mode_ok_21
    s_sleep 8
    s_sub_u32 s94, s94, 1
    s_cmp_lg_u32 s94, 0
    s_cbranch_scc1 L_mode_20
L_mode_ok_21:
    s_cmp_lg_u32 s93, 1
    s_cselect_b32 s64, 1, 0
    s_lshl_b32 s6, s82, 2
    v_mov_b32 v12, s6
    s_mov_b32 s94, 0x40000
L_kc_22:
    ds_read_b32 v13, v12 offset:16
    s_waitcnt lgkmcnt(0)
    v_readfirstlane_b32 s93, v13
    s_cmp_eq_u32 s93, 4
    s_cbranch_scc1 L_kc_ok_23
    s_sleep 8
    s_sub_u32 s94, s94, 1
    s_cmp_lg_u32 s94, 0
    s_cbranch_scc1 L_kc_22
L_kc_ok_23:
    s_lshl_b32 s6, s82, 9
    s_add_u32 s6, s6, 2048
    v_lshlrev_b32 v12, 3, v0
    v_add_u32 v12, s6, v12
    ds_read_b64 v[160:161], v12 offset:0
    ds_read_b64 v[162:163], v12 offset:2112
    ds_read_b64 v[164:165], v12 offset:4224
    ds_read_b64 v[166:167], v12 offset:6336
    v_mul_u32_u24 v12, 2112, v2
    v_lshl_add_u32 v12, v1, 2, v12
    ds_read_b32 v14, v12 offset:4096
    s_cmp_eq_u32 s82, 3
    s_cselect_b64 vcc, -1, 0
    v_mov_b32 v15, 0xff80ff80
    s_waitcnt lgkmcnt(0)
    v_cndmask_b32 v14, v15, v14, vcc
    v_lshlrev_b32 v168, 16, v160
    v_and_b32 v169, 0xffff0000, v160
    v_lshlrev_b32 v170, 16, v161
    v_and_b32 v171, 0xffff0000, v161
    v_lshlrev_b32 v172, 16, v162
    v_and_b32 v173, 0xffff0000, v162
    v_lshlrev_b32 v174, 16, v163
    v_and_b32 v175, 0xffff0000, v163
    v_lshlrev_b32 v176, 16, v164
    v_and_b32 v177, 0xffff0000, v164
    v_lshlrev_b32 v178, 16, v165
    v_and_b32 v179, 0xffff0000, v165
    v_lshlrev_b32 v180, 16, v166
    v_and_b32 v181, 0xffff0000, v166
    v_lshlrev_b32 v182, 16, v167
    v_and_b32 v183, 0xffff0000, v167
    v_lshlrev_b32 v184, 16, v14
    v_and_b32 v185, 0xffff0000, v14
    v_max3_f32 v12, v168, v169, v170
    v_max3_f32 v12, v12, v171, v172
    v_max3_f32 v12, v12, v173, v174
    v_max3_f32 v12, v12, v175, v176
    v_max3_f32 v12, v12, v177, v178
    v_max3_f32 v12, v12, v179, v180
    v_max3_f32 v12, v12, v181, v182
    v_max3_f32 v12, v12, v183, v184
    v_max_f32 v12, v12, v185
    s_nop 1
    v_max_f32_dpp v12, v12, v12 row_ror:8 row_mask:0xf bank_mask:0xf
    s_nop 1
    v_max_f32_dpp v12, v12, v12 row_ror:4 row_mask:0xf bank_mask:0xf
    s_nop 1
    v_max_f32_dpp v12, v12, v12 row_ror:2 row_mask:0xf bank_mask:0xf
    s_nop 1
    v_max_f32_dpp v12, v12, v12 row_ror:1 row_mask:0xf bank_mask:0xf
    v_mov_b32 v14, v12
    s_nop 1
    v_permlane16_swap_b32 v12, v14
    v_max_f32 v12, v12, v14
    v_mov_b32 v14, v12
    s_nop 1
    v_permlane32_swap_b32 v12, v14
    v_max_f32 v12, v12, v14
    v_sub_f32 v168, v168, v12
    v_sub_f32 v169, v169, v12
    v_sub_f32 v170, v170, v12
    v_sub_f32 v171, v171, v12
    v_sub_f32 v172, v172, v12
    v_sub_f32 v173, v173, v12
    v_sub_f32 v174, v174, v12
    v_sub_f32 v175, v175, v12
    v_sub_f32 v176, v176, v12
    v_sub_f32 v177, v177, v12
    v_sub_f32 v178, v178, v12
    v_sub_f32 v179, v179, v12
    v_sub_f32 v180, v180, v12
    v_sub_f32 v181, v181, v12
    v_sub_f32 v182, v182, v12
    v_sub_f32 v183, v183, v12
    v_sub_f32 v184, v184, v12
    v_sub_f32 v185, v185, v12
    v_mul_f32 v168, 0x3fb8aa3b, v168
    v_mul_f32 v169, 0x3fb8aa3b, v169
    v_mul_f32 v170, 0x3fb8aa3b, v170
    v_mul_f32 v171, 0x3fb8aa3b, v171
    v_mul_f32 v172, 0x3fb8aa3b, v172
    v_mul_f32 v173, 0x3fb8aa3b, v173
    v_mul_f32 v174, 0x3fb8aa3b, v174
    v_mul_f32 v175, 0x3fb8aa3b, v175
    v_mul_f32 v176, 0x3fb8aa3b, v176
    v_mul_f32 v177, 0x3fb8aa3b, v177
    v_mul_f32 v178, 0x3fb8aa3b, v178
    v_mul_f32 v179, 0x3fb8aa3b, v179
    v_mul_f32 v180, 0x3fb8aa3b, v180
    v_mul_f32 v181, 0x3fb8aa3b, v181
    v_mul_f32 v182, 0x3fb8aa3b, v182
    v_mul_f32 v183, 0x3fb8aa3b, v183
    v_mul_f32 v184, 0x3fb8aa3b, v184
    v_mul_f32 v185, 0x3fb8aa3b, v185
    v_exp_f32 v168, v168
    v_exp_f32 v169, v169
    v_exp_f32 v170, v170
    v_exp_f32 v171, v171
    v_exp_f32 v172, v172
    v_exp_f32 v173, v173
    v_exp_f32 v174, v174
    v_exp_f32 v175, v175
    v_exp_f32 v176, v176
    v_exp_f32 v177, v177
    v_exp_f32 v178, v178
    v_exp_f32 v179, v179
    v_exp_f32 v180, v180
    v_exp_f32 v181, v181
    v_exp_f32 v182, v182
    v_exp_f32 v183, v183
    v_exp_f32 v184, v184
    v_exp_f32 v185, v185
    v_add_f32 v168, v168, v184
    v_add_f32 v169, v169, v185
    v_add_f32 v168, v168, v176
    v_add_f32 v169, v169, v177
    v_add_f32 v170, v170, v178
    v_add_f32 v171, v171, v179
    v_add_f32 v172, v172, v180
    v_add_f32 v173, v173, v181
    v_add_f32 v174, v174, v182
    v_add_f32 v175, v175, v183
    v_add_f32 v168, v168, v172
    v_add_f32 v169, v169, v173
    v_add_f32 v170, v170, v174
    v_add_f32 v171, v171, v175
    v_add_f32 v168, v168, v170
    v_add_f32 v169, v169, v171
    v_add_f32 v168, v168, v169
    v_mov_b32 v13, v168
    s_nop 1
    v_add_f32_dpp v13, v13, v13 row_ror:8 row_mask:0xf bank_mask:0xf
    s_nop 1
    v_add_f32_dpp v13, v13, v13 row_ror:4 row_mask:0xf bank_mask:0xf
    s_nop 1
    v_add_f32_dpp v13, v13, v13 row_ror:2 row_mask:0xf bank_mask:0xf
    s_nop 1
    v_add_f32_dpp v13, v13, v13 row_ror:1 row_mask:0xf bank_mask:0xf
    v_mov_b32 v14, v13
    s_nop 1
    v_permlane16_swap_b32 v13, v14
    v_add_f32 v13, v13, v14
    v_mov_b32 v14, v13
    s_nop 1
    v_permlane32_swap_b32 v13, v14
    v_add_f32 v13, v13, v14
    v_mov_b32 v14, s58
    v_mov_b32 v15, s58
    s_mov_b64 exec, 1
    s_cmp_lg_u32 s64, 0
    s_cbranch_scc1 L_dev_24
    buffer_store_dwordx4 v[12:15], v32, s[16:19], s10 offen
L_devb_25:
    s_mov_b64 exec, -1
    v_and_b32 v18, 7, v0
    v_lshlrev_b32 v18, 4, v18
    s_mov_b32 s94, 0x8000
L_stpoll:
    s_sleep 32
    buffer_load_dwordx4 v[12:15], v18, s[16:19], s9 offen sc1
    s_waitcnt vmcnt(0)
    v_cmp_ne_u32 vcc, s58, v15
    s_cbranch_vccz L_stok
    s_sub_u32 s94, s94, 1
    s_cmp_lg_u32 s94, 0
    s_cbranch_scc1 L_stpoll
L_stok:
    v_mov_b32 v16, v12
    s_nop 1
    v_max_f32_dpp v16, v16, v16 quad_perm:[1,0,3,2] row_mask:0xf bank_mask:0xf
    s_nop 1
    v_max_f32_dpp v16, v16, v16 quad_perm:[2,3,0,1] row_mask:0xf bank_mask:0xf
    s_nop 1
    v_max_f32_dpp v16, v16, v16 row_half_mirror row_mask:0xf bank_mask:0xf
    v_sub_f32 v12, v12, v16
    v_mul_f32 v12, 0x3fb8aa3b, v12
    v_exp_f32 v12, v12
    s_nop 0
    v_mul_f32 v17, v12, v13
    s_nop 1
    v_add_f32_dpp v17, v17, v17 quad_perm:[1,0,3,2] row_mask:0xf bank_mask:0xf
    s_nop 1
    v_add_f32_dpp v17, v17, v17 quad_perm:[2,3,0,1] row_mask:0xf bank_mask:0xf
    s_nop 1
    v_add_f32_dpp v17, v17, v17 row_half_mirror row_mask:0xf bank_mask:0xf
    s_add_u32 s6, s64, 1
    v_rcp_f32 v17, v17
    v_mov_b32 v18, s6
    v_mov_b32 v19, 0
    s_lshl_b32 s6, s82, 4
    v_mov_b32 v12, s6
    s_mov_b64 exec, 1
    ds_write_b128 v12, v[16:19] offset:64
    s_mov_b64 exec, -1
    v_lshrrev_b32 v43, 1, v1
    v_lshlrev_b32 v43, 5, v43
    v_lshl_add_u32 v43, v2, 3, v43
    v_and_b32 v12, 1, v1
    v_lshl_add_u32 v43, v12, 2, v43
    v_mov_b32 v45, 48
    v_lshlrev_b32 v46, 2, v43
    v_lshrrev_b32 v34, 1, v46
    v_and_b32 v34, 24, v34
    v_bfe_u32 v34, s58, v34, 8
    v_mul_u32_u24 v5, 192, v2
    v_lshl_add_u32 v5, v1, 4, v5
    s_mov_b32 s65, 0
    s_cmp_eq_u32 s88, 1
    s_cbranch_scc1 L_brole
    s_cmp_eq_u32 s82, 1
    s_cbranch_scc1 L_side
    s_cmp_lg_u32 s82, 3
    s_cbranch_scc1 L_lr_out_26
    s_lshl_b32 s69, s89, 9
    s_add_u32 s69, s69, 1952768
    v_lshlrev_b32 v14, 2, v0
    s_mov_b32 s94, 0x40000
L_lrs_27:
    ds_read_b32 v12, v32 offset:4
    s_waitcnt lgkmcnt(0)
    v_readfirstlane_b32 s93, v12
    s_cmp_ge_u32 s93, 192
    s_cbranch_scc1 L_lrs_ok_28
    s_sleep 8
    s_sub_u32 s94, s94, 1
    s_cmp_lg_u32 s94, 0
    s_cbranch_scc1 L_lrs_27
L_lrs_ok_28:
    s_mov_b32 exec_lo, 0xffffffff
    s_mov_b32 exec_hi, 0x0
    buffer_load_dword v15, v14, s[16:19], s69 offen sc1
    s_waitcnt vmcnt(0)
    v_cmp_eq_u32 vcc, s58, v15
    s_mov_b64 exec, -1
    s_bcnt1_i32_b32 s6, vcc_lo
    s_mul_i32 s6, s6, 80
    s_add_i32 s6, s6, 0
    s_max_i32 s6, s6, 0
    s_lshr_b32 s6, s6, 8
    s_min_u32 s6, s6, 7
    v_mov_b32 v12, s6
    ds_write_b32 v32, v12 offset:144
L_lr_out_26:
    s_cmp_lg_u32 s82, 2
    s_cbranch_scc1 L_mk0
    s_cmp_lt_u32 s5, 6
    s_cbranch_scc1 L_claimw
    s_and_b32 s6, s4, 3
    s_mul_i32 s66, s6, 8
    s_add_u32 s66, s66, 196
    s_lshl_b32 s68, s4, 2
    s_add_u32 s68, s68, 1952768
    v_lshlrev_b32 v16, 9, v0
    v_mov_b32 v17, s58
    s_mov_b32 s94, 0x40000
L_lps_29:
    ds_read_b32 v12, v32 offset:4
    s_waitcnt lgkmcnt(0)
    v_readfirstlane_b32 s93, v12
    s_cmp_ge_u32 s93, s66
    s_cbranch_scc1 L_lps_ok_30
    s_sleep 8
    s_sub_u32 s94, s94, 1
    s_cmp_lg_u32 s94, 0
    s_cbranch_scc1 L_lps_29
L_lps_ok_30:
    s_mov_b64 exec, 0xff
    buffer_store_dword v17, v16, s[16:19], s68 offen sc1
    s_branch L_claimw
L_mk0:
    s_cmp_lg_u32 s82, 0
    s_cbranch_scc1 L_claim
L_mk:
    s_lshl_b32 s6, s65, 2
    v_mov_b32 v13, s6
    s_mov_b32 s94, 0x40000
L_vc_31:
    ds_read_b32 v12, v13 offset:32
    s_waitcnt lgkmcnt(0)
    v_readfirstlane_b32 s93, v12
    s_cmp_eq_u32 s93, 4
    s_cbranch_scc1 L_vc_ok_32
    s_sleep 8
    s_sub_u32 s94, s94, 1
    s_cmp_lg_u32 s94, 0
    s_cbranch_scc1 L_vc_31
L_vc_ok_32:
    s_mul_i32 s6, s65, 6144
    s_add_u32 s7, s8, s6
    v_add_u32 v13, s6, v4
    s_mov_b32 exec_lo, 0xffffffff
    s_mov_b32 exec_hi, 0xffff
    ds_read_b128 v[160:163], v13 offset:10496
    ds_read_b128 v[164:167], v13 offset:11264
    ds_read_b128 v[168:171], v13 offset:12032
    ds_read_b128 v[172:175], v13 offset:12800
    ds_read_b128 v[176:179], v13 offset:13568
    ds_read_b128 v[180:183], v13 offset:14336
    ds_read_b128 v[184:187], v13 offset:15104
    ds_read_b128 v[188:191], v13 offset:15872
    s_waitcnt lgkmcnt(6)
    v_pk_add_f32 v[160:161], v[160:161], v[164:165]
    v_pk_add_f32 v[162:163], v[162:163], v[166:167]
    s_waitcnt lgkmcnt(4)
    v_pk_add_f32 v[168:169], v[168:169], v[172:173]
    v_pk_add_f32 v[170:171], v[170:171], v[174:175]
    s_waitcnt lgkmcnt(2)
    v_pk_add_f32 v[176:177], v[176:177], v[180:181]
    v_pk_add_f32 v[178:179], v[178:179], v[182:183]
    s_waitcnt lgkmcnt(0)
    v_pk_add_f32 v[184:185], v[184:185], v[188:189]
    v_pk_add_f32 v[186:187], v[186:187], v[190:191]
    v_pk_add_f32 v[160:161], v[160:161], v[168:169]
    v_pk_add_f32 v[162:163], v[162:163], v[170:171]
    v_pk_add_f32 v[176:177], v[176:177], v[184:185]
    v_pk_add_f32 v[178:179], v[178:179], v[186:187]
    v_pk_add_f32 v[160:161], v[160:161], v[176:177]
    v_pk_add_f32 v[162:163], v[162:163], v[178:179]
    v_and_or_b32 v163, v163, s59, v35
    s_cmp_lg_u32 s64, 0
    s_cbranch_scc1 L_dev_33
    buffer_store_dwordx4 v[160:163], v4, s[16:19], s7 offen
L_devb_34:
    s_lshl_b32 s6, s65, 10
    s_lshl_b32 s7, s2, 2
    s_add_u32 s6, s6, s7
    s_add_u32 s6, s6, 1868032
    v_mov_b32 v12, s58
    s_mov_b64 exec, 1
    s_waitcnt vmcnt(0)
    s_cmp_lg_u32 s64, 0
    s_cbranch_scc1 L_dev_35
    buffer_store_dword v12, v32, s[16:19], s6 offen
L_devb_36:
    s_mov_b64 exec, -1
    s_add_u32 s65, s65, 1
    s_cmp_lt_u32 s65, 3
    s_cbranch_scc1 L_mk
    s_branch L_claimw
L_claim:
    s_cmp_le_u32 s6, 2
    s_cselect_b32 s66, 249, s56
    s_mov_b32 s94, 0x40000
L_cl_37:
    ds_read_b32 v12, v32 offset:4
    s_waitcnt lgkmcnt(0)
    v_readfirstlane_b32 s93, v12
    s_cmp_ge_u32 s93, s66
    s_cbranch_scc1 L_cl_ok_38
    s_sleep 4
    s_sub_u32 s94, s94, 1
    s_cmp_lg_u32 s94, 0
    s_cbranch_scc1 L_cl_37
L_cl_ok_38:
    v_mov_b32 v14, 1
    s_mov_b64 exec, 1
    buffer_atomic_add v14, v32, s[52:55], 0 offen offset:4 sc0 sc1
    s_waitcnt vmcnt(0)
    v_add_u32 v14, 1, v14
    ds_write_b32 v32, v14 offset:148
L_claimw:
    s_mov_b64 exec, -1
    s_mov_b32 s94, 0x40000
L_clw_39:
    ds_read_b32 v12, v32 offset:148
    s_waitcnt lgkmcnt(0)
    v_readfirstlane_b32 s93, v12
    s_cmp_lg_u32 s93, 0
    s_cbranch_scc1 L_clw_ok_40
    s_sleep 3
    s_sub_u32 s94, s94, 1
    s_cmp_lg_u32 s94, 0
    s_cbranch_scc1 L_clw_39
L_clw_ok_40:
    s_sub_u32 s91, s93, 1
    s_cbranch_scc1 L_end
    s_mul_hi_u32 s6, s91, 0x1745d18
    s_mul_i32 s6, s6, 176
    s_sub_u32 s91, s91, s6
    s_cmp_ge_u32 s91, 48
    s_cbranch_scc1 L_end
    s_mov_b32 s65, 0
    s_branch L_crole
L_side:
    s_cmp_eq_u32 s88, 2
    s_cbranch_scc1 L_claimw
    v_mov_b32 v27, s58
    s_cmp_eq_u32 s88, 0
    s_cbranch_scc1 L_hrole
    s_mov_b32 s65, s85
    s_lshl_b32 s6, s4, 2
    s_add_u32 s6, s6, s65
    s_mul_i32 s70, s6, 6144
    s_add_u32 s70, s70, 508160
    s_add_u32 s71, s70, 3072
    s_mul_i32 s6, s4, 3
    s_add_u32 s6, s6, s65
    s_mul_i32 s72, s6, 768
    s_add_u32 s72, s72, 1871104
    s_lshl_b32 s73, s65, 10
    s_lshl_b32 s6, s4, 5
    s_add_u32 s73, s73, s6
    s_add_u32 s73, s73, 1868032
    s_lshl_b32 s66, s65, 6
    s_add_u32 s66, s66, 68
    s_mov_b32 s94, 0x40000
L_gate_41:
    ds_read_b32 v12, v32 offset:4
    s_waitcnt lgkmcnt(0)
    v_readfirstlane_b32 s93, v12
    s_cmp_ge_u32 s93, s66
    s_cbranch_scc1 L_gate_ok_42
    s_sleep 8
    s_sub_u32 s94, s94, 1
    s_cmp_lg_u32 s94, 0
    s_cbranch_scc1 L_gate_41
L_gate_ok_42:
    v_lshlrev_b32 v13, 2, v0
    s_mov_b32 s94, 0x8000
    s_cmp_eq_u32 s65, 2
    s_cbranch_scc1 L_rok
    s_mov_b64 exec, 0xff
L_rp:
    buffer_load_dword v12, v13, s[16:19], s73 offen sc1
    s_waitcnt vmcnt(0)
    v_cmp_ne_u32 vcc, s58, v12
    s_cbranch_vccz L_rok
    s_sleep 24
    s_sub_u32 s94, s94, 1
    s_cmp_lg_u32 s94, 0
    s_cbranch_scc1 L_rp
L_rok:
    s_mov_b32 exec_lo, 0xfff0fff
    s_mov_b32 exec_hi, 0xfff0fff
    buffer_load_dwordx4 v[28:31], v5, s[16:19], s72 offen sc1 nt
    s_mov_b32 s67, 255
    s_mov_b32 s94, 0x8000
    s_mov_b32 exec_lo, 0xfff0fff
    s_mov_b32 exec_hi, 0xfff0fff
L_rp_poll_43:
    s_bitcmp1_b32 s67, 0
    s_cselect_b32 s68, -1, 0
    s_cbranch_scc0 L_rp_sk_45
    buffer_load_dwordx4 v[160:163], v46, s[16:19], s70 offen offset:0 sc1 nt
L_rp_sk_45:
    s_bitcmp1_b32 s67, 1
    s_cselect_b32 s69, -1, 0
    s_cbranch_scc0 L_rp_sk_46
    buffer_load_dwordx4 v[164:167], v46, s[16:19], s70 offen offset:768 sc1 nt
L_rp_sk_46:
    s_bitcmp1_b32 s67, 2
    s_cselect_b32 s77, -1, 0
    s_cbranch_scc0 L_rp_sk_47
    buffer_load_dwordx4 v[168:171], v46, s[16:19], s70 offen offset:1536 sc1 nt
L_rp_sk_47:
    s_bitcmp1_b32 s67, 3
    s_cselect_b32 s83, -1, 0
    s_cbranch_scc0 L_rp_sk_48
    buffer_load_dwordx4 v[172:175], v46, s[16:19], s70 offen offset:2304 sc1 nt
L_rp_sk_48:
    s_bitcmp1_b32 s67, 4
    s_cselect_b32 s84, -1, 0
    s_cbranch_scc0 L_rp_sk_49
    buffer_load_dwordx4 v[176:179], v46, s[16:19], s71 offen offset:0 sc1 nt
L_rp_sk_49:
    s_bitcmp1_b32 s67, 5
    s_cselect_b32 s85, -1, 0
    s_cbranch_scc0 L_rp_sk_50
    buffer_load_dwordx4 v[180:183], v46, s[16:19], s71 offen offset:768 sc1 nt
L_rp_sk_50:
    s_bitcmp1_b32 s67, 6
    s_cselect_b32 s86, -1, 0
    s_cbranch_scc0 L_rp_sk_51
    buffer_load_dwordx4 v[184:187], v46, s[16:19], s71 offen offset:1536 sc1 nt
L_rp_sk_51:
    s_bitcmp1_b32 s67, 7
    s_cselect_b32 s87, -1, 0
    s_cbranch_scc0 L_rp_sk_52
    buffer_load_dwordx4 v[188:191], v46, s[16:19], s71 offen offset:2304 sc1 nt
L_rp_sk_52:
    s_waitcnt vmcnt(0)
    v_bitop3_b32 v163, v163, v34, s68 bitop3:0x78
    v_bitop3_b32 v167, v167, v34, s69 bitop3:0x78
    v_bitop3_b32 v171, v171, v34, s77 bitop3:0x78
    v_bitop3_b32 v175, v175, v34, s83 bitop3:0x78
    v_bitop3_b32 v179, v179, v34, s84 bitop3:0x78
    v_bitop3_b32 v183, v183, v34, s85 bitop3:0x78
    v_bitop3_b32 v187, v187, v34, s86 bitop3:0x78
    v_bitop3_b32 v191, v191, v34, s87 bitop3:0x78
    v_or3_b32 v24, v163, v167, v171
    v_or3_b32 v24, v24, v175, v179
    v_or3_b32 v24, v24, v183, v187
    v_or_b32 v24, v24, v191
    v_cmp_ne_u32_sdwa vcc, v24, v32 src0_sel:BYTE_0 src1_sel:DWORD
    s_cbranch_vccz L_rp_ok_44
    s_mov_b32 s67, 0
    v_cmp_ne_u32_sdwa vcc, v163, v32 src0_sel:BYTE_0 src1_sel:DWORD
    s_cmp_lg_u64 vcc, 0
    s_cselect_b32 s6, 1, 0
    s_or_b32 s67, s67, s6
    v_cmp_ne_u32_sdwa vcc, v167, v32 src0_sel:BYTE_0 src1_sel:DWORD
    s_cmp_lg_u64 vcc, 0
    s_cselect_b32 s6, 2, 0
    s_or_b32 s67, s67, s6
    v_cmp_ne_u32_sdwa vcc, v171, v32 src0_sel:BYTE_0 src1_sel:DWORD
    s_cmp_lg_u64 vcc, 0
    s_cselect_b32 s6, 4, 0
    s_or_b32 s67, s67, s6
    v_cmp_ne_u32_sdwa vcc, v175, v32 src0_sel:BYTE_0 src1_sel:DWORD
    s_cmp_lg_u64 vcc, 0
    s_cselect_b32 s6, 8, 0
    s_or_b32 s67, s67, s6
    v_cmp_ne_u32_sdwa vcc, v179, v32 src0_sel:BYTE_0 src1_sel:DWORD
    s_cmp_lg_u64 vcc, 0
    s_cselect_b32 s6, 16, 0
    s_or_b32 s67, s67, s6
    v_cmp_ne_u32_sdwa vcc, v183, v32 src0_sel:BYTE_0 src1_sel:DWORD
    s_cmp_lg_u64 vcc, 0
    s_cselect_b32 s6, 32, 0
    s_or_b32 s67, s67, s6
    v_cmp_ne_u32_sdwa vcc, v187, v32 src0_sel:BYTE_0 src1_sel:DWORD
    s_cmp_lg_u64 vcc, 0
    s_cselect_b32 s6, 64, 0
    s_or_b32 s67, s67, s6
    v_cmp_ne_u32_sdwa vcc, v191, v32 src0_sel:BYTE_0 src1_sel:DWORD
    s_cmp_lg_u64 vcc, 0
    s_cselect_b32 s6, 128, 0
    s_or_b32 s67, s67, s6
    s_sleep 16
    s_sub_u32 s94, s94, 1
    s_cmp_lg_u32 s94, 0
    s_cbranch_scc1 L_rp_poll_43
L_rp_ok_44:
    v_pk_add_f32 v[8:9], v[160:161], v[164:165]
    v_pk_add_f32 v[10:11], v[162:163], v[166:167]
    v_pk_add_f32 v[12:13], v[168:169], v[172:173]
    v_pk_add_f32 v[14:15], v[170:171], v[174:175]
    v_pk_add_f32 v[16:17], v[176:177], v[180:181]
    v_pk_add_f32 v[18:19], v[178:179], v[182:183]
    v_pk_add_f32 v[20:21], v[184:185], v[188:189]
    v_pk_add_f32 v[22:23], v[186:187], v[190:191]
    v_pk_add_f32 v[8:9], v[8:9], v[12:13]
    v_pk_add_f32 v[10:11], v[10:11], v[14:15]
    v_pk_add_f32 v[16:17], v[16:17], v[20:21]
    v_pk_add_f32 v[18:19], v[18:19], v[22:23]
    v_pk_add_f32 v[8:9], v[8:9], v[16:17]
    v_pk_add_f32 v[10:11], v[10:11], v[18:19]
    v_cvt_pk_bf16_f32 v24, v8, v9
    v_cvt_pk_bf16_f32 v25, v10, v11
    s_cmp_lg_u32 s64, 0
    s_cbranch_scc1 L_dev_53
    buffer_store_dwordx4 v[24:27], v5, s[16:19], s72 offen
L_devb_54:
    s_branch L_claimw
L_hrole:
    s_cmp_ge_u32 s4, 8
    s_cbranch_scc1 L_claimw
    s_lshr_b32 s65, s4, 2
    s_and_b32 s74, s4, 3
    s_mul_i32 s6, s74, 160
    v_add_u32 v46, s6, v43
    v_lshlrev_b32 v49, 1, v46
    v_lshlrev_b32 v46, 2, v46
    s_mul_i32 s6, s65, 1280
    buffer_load_dwordx2 v[58:59], v49, s[20:23], s6 offen
    s_mul_i32 s70, s65, 20480
    s_add_u32 s70, s70, 1294592
    s_add_u32 s71, s70, 5120
    s_add_u32 s72, s70, 10240
    s_add_u32 s73, s70, 15360
    s_mul_i32 s6, s74, 640
    v_mul_u32_u24 v5, 160, v2
    v_lshl_add_u32 v5, v1, 4, v5
    v_add_u32 v5, s6, v5
    s_waitcnt vmcnt(0)
    v_lshlrev_b32 v60, 16, v58
    v_and_b32 v61, 0xffff0000, v58
    v_lshlrev_b32 v62, 16, v59
    v_and_b32 v63, 0xffff0000, v59
    s_mul_i32 s75, s65, 2560
    s_add_u32 s75, s75, 1944832
    s_mov_b32 exec_lo, 0x3ff03ff
    s_mov_b32 exec_hi, 0x3ff03ff
    buffer_load_dwordx4 v[28:31], v5, s[16:19], s75 offen sc1
    s_mov_b64 exec, -1
    s_lshl_b32 s66, s65, 6
    s_add_u32 s66, s66, 104
    s_mov_b32 s94, 0x40000
L_gate_55:
    ds_read_b32 v12, v32 offset:4
    s_waitcnt lgkmcnt(0)
    v_readfirstlane_b32 s93, v12
    s_cmp_ge_u32 s93, s66
    s_cbranch_scc1 L_gate_ok_56
    s_sleep 8
    s_sub_u32 s94, s94, 1
    s_cmp_lg_u32 s94, 0
    s_cbranch_scc1 L_gate_55
L_gate_ok_56:
    s_mov_b32 s67, 255
    s_mov_b32 s94, 0x8000
    s_mov_b32 exec_lo, 0x3ff03ff
    s_mov_b32 exec_hi, 0x3ff03ff
L_hy_poll_57:
    s_bitcmp1_b32 s67, 0
    s_cselect_b32 s68, -1, 0
    s_cbranch_scc0 L_hy_sk_59
    buffer_load_dwordx4 v[160:163], v46, s[16:19], s70 offen offset:0 sc1 nt
L_hy_sk_59:
    s_bitcmp1_b32 s67, 1
    s_cselect_b32 s69, -1, 0
    s_cbranch_scc0 L_hy_sk_60
    buffer_load_dwordx4 v[164:167], v46, s[16:19], s70 offen offset:2560 sc1 nt
L_hy_sk_60:
    s_bitcmp1_b32 s67, 2
    s_cselect_b32 s77, -1, 0
    s_cbranch_scc0 L_hy_sk_61
    buffer_load_dwordx4 v[168:171], v46, s[16:19], s71 offen offset:0 sc1 nt
L_hy_sk_61:
    s_bitcmp1_b32 s67, 3
    s_cselect_b32 s83, -1, 0
    s_cbranch_scc0 L_hy_sk_62
    buffer_load_dwordx4 v[172:175], v46, s[16:19], s71 offen offset:2560 sc1 nt
L_hy_sk_62:
    s_bitcmp1_b32 s67, 4
    s_cselect_b32 s84, -1, 0
    s_cbranch_scc0 L_hy_sk_63
    buffer_load_dwordx4 v[176:179], v46, s[16:19], s72 offen offset:0 sc1 nt
L_hy_sk_63:
    s_bitcmp1_b32 s67, 5
    s_cselect_b32 s85, -1, 0
    s_cbranch_scc0 L_hy_sk_64
    buffer_load_dwordx4 v[180:183], v46, s[16:19], s72 offen offset:2560 sc1 nt
L_hy_sk_64:
    s_bitcmp1_b32 s67, 6
    s_cselect_b32 s86, -1, 0
    s_cbranch_scc0 L_hy_sk_65
    buffer_load_dwordx4 v[184:187], v46, s[16:19], s73 offen offset:0 sc1 nt
L_hy_sk_65:
    s_bitcmp1_b32 s67, 7
    s_cselect_b32 s87, -1, 0
    s_cbranch_scc0 L_hy_sk_66
    buffer_load_dwordx4 v[188:191], v46, s[16:19], s73 offen offset:2560 sc1 nt
L_hy_sk_66:
    s_waitcnt vmcnt(0)
    v_bitop3_b32 v163, v163, v34, s68 bitop3:0x78
    v_bitop3_b32 v167, v167, v34, s69 bitop3:0x78
    v_bitop3_b32 v171, v171, v34, s77 bitop3:0x78
    v_bitop3_b32 v175, v175, v34, s83 bitop3:0x78
    v_bitop3_b32 v179, v179, v34, s84 bitop3:0x78
    v_bitop3_b32 v183, v183, v34, s85 bitop3:0x78
    v_bitop3_b32 v187, v187, v34, s86 bitop3:0x78
    v_bitop3_b32 v191, v191, v34, s87 bitop3:0x78
    v_or3_b32 v26, v163, v167, v171
    v_or3_b32 v26, v26, v175, v179
    v_or3_b32 v26, v26, v183, v187
    v_or_b32 v26, v26, v191
    v_cmp_ne_u32_sdwa vcc, v26, v32 src0_sel:BYTE_0 src1_sel:DWORD
    s_cbranch_vccz L_hy_ok_58
    s_mov_b32 s67, 0
    v_cmp_ne_u32_sdwa vcc, v163, v32 src0_sel:BYTE_0 src1_sel:DWORD
    s_cmp_lg_u64 vcc, 0
    s_cselect_b32 s6, 1, 0
    s_or_b32 s67, s67, s6
    v_cmp_ne_u32_sdwa vcc, v167, v32 src0_sel:BYTE_0 src1_sel:DWORD
    s_cmp_lg_u64 vcc, 0
    s_cselect_b32 s6, 2, 0
    s_or_b32 s67, s67, s6
    v_cmp_ne_u32_sdwa vcc, v171, v32 src0_sel:BYTE_0 src1_sel:DWORD
    s_cmp_lg_u64 vcc, 0
    s_cselect_b32 s6, 4, 0
    s_or_b32 s67, s67, s6
    v_cmp_ne_u32_sdwa vcc, v175, v32 src0_sel:BYTE_0 src1_sel:DWORD
    s_cmp_lg_u64 vcc, 0
    s_cselect_b32 s6, 8, 0
    s_or_b32 s67, s67, s6
    v_cmp_ne_u32_sdwa vcc, v179, v32 src0_sel:BYTE_0 src1_sel:DWORD
    s_cmp_lg_u64 vcc, 0
    s_cselect_b32 s6, 16, 0
    s_or_b32 s67, s67, s6
    v_cmp_ne_u32_sdwa vcc, v183, v32 src0_sel:BYTE_0 src1_sel:DWORD
    s_cmp_lg_u64 vcc, 0
    s_cselect_b32 s6, 32, 0
    s_or_b32 s67, s67, s6
    v_cmp_ne_u32_sdwa vcc, v187, v32 src0_sel:BYTE_0 src1_sel:DWORD
    s_cmp_lg_u64 vcc, 0
    s_cselect_b32 s6, 64, 0
    s_or_b32 s67, s67, s6
    v_cmp_ne_u32_sdwa vcc, v191, v32 src0_sel:BYTE_0 src1_sel:DWORD
    s_cmp_lg_u64 vcc, 0
    s_cselect_b32 s6, 128, 0
    s_or_b32 s67, s67, s6
    s_sleep 16
    s_sub_u32 s94, s94, 1
    s_cmp_lg_u32 s94, 0
    s_cbranch_scc1 L_hy_poll_57
L_hy_ok_58:
    v_pk_add_f32 v[8:9], v[160:161], v[164:165]
    v_pk_add_f32 v[10:11], v[162:163], v[166:167]
    v_pk_add_f32 v[12:13], v[168:169], v[172:173]
    v_pk_add_f32 v[14:15], v[170:171], v[174:175]
    v_pk_add_f32 v[16:17], v[176:177], v[180:181]
    v_pk_add_f32 v[18:19], v[178:179], v[182:183]
    v_pk_add_f32 v[20:21], v[184:185], v[188:189]
    v_pk_add_f32 v[22:23], v[186:187], v[190:191]
    v_pk_add_f32 v[8:9], v[8:9], v[12:13]
    v_pk_add_f32 v[10:11], v[10:11], v[14:15]
    v_pk_add_f32 v[16:17], v[16:17], v[20:21]
    v_pk_add_f32 v[18:19], v[18:19], v[22:23]
    v_pk_add_f32 v[8:9], v[8:9], v[16:17]
    v_pk_add_f32 v[10:11], v[10:11], v[18:19]
    v_cvt_pk_bf16_f32 v12, v8, v9
    v_cvt_pk_bf16_f32 v13, v10, v11
    v_lshlrev_b32 v8, 16, v12
    v_and_b32 v9, 0xffff0000, v12
    v_lshlrev_b32 v10, 16, v13
    v_and_b32 v11, 0xffff0000, v13
    v_pk_add_f32 v[8:9], v[8:9], v[60:61]
    v_pk_add_f32 v[10:11], v[10:11], v[62:63]
    v_cvt_pk_bf16_f32 v24, v8, v9
    v_cvt_pk_bf16_f32 v25, v10, v11
    buffer_store_dwordx4 v[24:27], v5, s[16:19], s75 offen sc1
    s_branch L_claimw
L_bearly:
    s_cmp_lg_u32 s65, 2
    s_cbranch_scc1 L_bnolag
    s_cmp_lg_u32 s82, 3
    s_cbranch_scc1 L_lr_out_67
    s_lshl_b32 s69, s89, 9
    s_add_u32 s69, s69, 1952768
    v_lshlrev_b32 v14, 2, v0
    s_mov_b32 s94, 0x40000
L_lrs_68:
    ds_read_b32 v12, v32 offset:4
    s_waitcnt lgkmcnt(0)
    v_readfirstlane_b32 s93, v12
    s_cmp_ge_u32 s93, 192
    s_cbranch_scc1 L_lrs_ok_69
    s_sleep 8
    s_sub_u32 s94, s94, 1
    s_cmp_lg_u32 s94, 0
    s_cbranch_scc1 L_lrs_68
L_lrs_ok_69:
    s_mov_b32 exec_lo, 0xffffffff
    s_mov_b32 exec_hi, 0x0
    buffer_load_dword v15, v14, s[16:19], s69 offen sc1
    s_waitcnt vmcnt(0)
    v_cmp_eq_u32 vcc, s58, v15
    s_mov_b64 exec, -1
    s_bcnt1_i32_b32 s6, vcc_lo
    s_mul_i32 s6, s6, 80
    s_add_i32 s6, s6, 0
    s_max_i32 s6, s6, 0
    s_lshr_b32 s6, s6, 8
    s_min_u32 s6, s6, 7
    v_mov_b32 v12, s6
    ds_write_b32 v32, v12 offset:144
L_lr_out_67:
L_bnolag:
    s_cmp_lg_u32 s82, 0
    s_cbranch_scc1 L_b_oth_70
    s_lshl_b32 s6, s65, 2
    v_mov_b32 v13, s6
    s_mov_b32 s94, 0x40000
L_vc_72:
    ds_read_b32 v12, v13 offset:32
    s_waitcnt lgkmcnt(0)
    v_readfirstlane_b32 s93, v12
    s_cmp_eq_u32 s93, 4
    s_cbranch_scc1 L_vc_ok_73
    s_sleep 8
    s_sub_u32 s94, s94, 1
    s_cmp_lg_u32 s94, 0
    s_cbranch_scc1 L_vc_72
L_vc_ok_73:
    s_mul_i32 s6, s65, 6144
    s_add_u32 s7, s8, s6
    v_add_u32 v13, s6, v4
    s_mov_b32 exec_lo, 0xffffffff
    s_mov_b32 exec_hi, 0xffff
    ds_read_b128 v[160:163], v13 offset:10496
    ds_read_b128 v[164:167], v13 offset:11264
    ds_read_b128 v[168:171], v13 offset:12032
    ds_read_b128 v[172:175], v13 offset:12800
    ds_read_b128 v[176:179], v13 offset:13568
    ds_read_b128 v[180:183], v13 offset:14336
    ds_read_b128 v[184:187], v13 offset:15104
    ds_read_b128 v[188:191], v13 offset:15872
    s_waitcnt lgkmcnt(6)
    v_pk_add_f32 v[160:161], v[160:161], v[164:165]
    v_pk_add_f32 v[162:163], v[162:163], v[166:167]
    s_waitcnt lgkmcnt(4)
    v_pk_add_f32 v[168:169], v[168:169], v[172:173]
    v_pk_add_f32 v[170:171], v[170:171], v[174:175]
    s_waitcnt lgkmcnt(2)
    v_pk_add_f32 v[176:177], v[176:177], v[180:181]
    v_pk_add_f32 v[178:179], v[178:179], v[182:183]
    s_waitcnt lgkmcnt(0)
    v_pk_add_f32 v[184:185], v[184:185], v[188:189]
    v_pk_add_f32 v[186:187], v[186:187], v[190:191]
    v_pk_add_f32 v[160:161], v[160:161], v[168:169]
    v_pk_add_f32 v[162:163], v[162:163], v[170:171]
    v_pk_add_f32 v[176:177], v[176:177], v[184:185]
    v_pk_add_f32 v[178:179], v[178:179], v[186:187]
    v_pk_add_f32 v[160:161], v[160:161], v[176:177]
    v_pk_add_f32 v[162:163], v[162:163], v[178:179]
    v_and_or_b32 v163, v163, s59, v35
    s_cmp_lg_u32 s64, 0
    s_cbranch_scc1 L_dev_74
    buffer_store_dwordx4 v[160:163], v4, s[16:19], s7 offen
L_devb_75:
    s_lshl_b32 s6, s65, 10
    s_lshl_b32 s7, s2, 2
    s_add_u32 s6, s6, s7
    s_add_u32 s6, s6, 1868032
    v_mov_b32 v12, s58
    s_mov_b64 exec, 1
    s_waitcnt vmcnt(0)
    s_cmp_lg_u32 s64, 0
    s_cbranch_scc1 L_dev_76
    buffer_store_dword v12, v32, s[16:19], s6 offen
L_devb_77:
    s_mov_b64 exec, -1
L_b_oth_70:
    s_lshl_b32 s66, s65, 6
    s_add_u32 s66, s66, 74
    s_mov_b32 s94, 0x40000
L_gate_78:
    ds_read_b32 v12, v32 offset:4
    s_waitcnt lgkmcnt(0)
    v_readfirstlane_b32 s93, v12
    s_cmp_ge_u32 s93, s66
    s_cbranch_scc1 L_gate_ok_79
    s_sleep 8
    s_sub_u32 s94, s94, 1
    s_cmp_lg_u32 s94, 0
    s_cbranch_scc1 L_gate_78
L_gate_ok_79:
    s_mov_b32 s94, 0x8000
    s_mov_b32 exec_lo, 0xfff0fff
    s_mov_b32 exec_hi, 0xfff0fff
L_b_top_71:
    buffer_load_dwordx4 v[24:27], v5, s[16:19], s73 offen sc1
    s_waitcnt vmcnt(0)
    v_cmp_ne_u32 vcc, s58, v27
    s_cbranch_vccz L_bgo
    s_sleep 16
    s_sub_u32 s94, s94, 1
    s_cmp_lg_u32 s94, 0
    s_cbranch_scc1 L_b_top_71
    s_branch L_bgo
L_brole:
    v_add_u32 v47, 35072, v4
    s_lshl_b32 s6, s82, 8
    v_add_u32 v44, s6, v47
    s_mul_i32 s70, s92, 24576
    s_add_u32 s70, s70, 526592
    s_add_u32 s71, s70, 3072
    s_mul_i32 s72, s89, 2560
    s_lshl_b32 s6, s90, 8
    s_add_u32 s72, s72, s6
    s_add_u32 s72, s72, 1294592
    s_mul_i32 s73, s92, 2304
    s_add_u32 s73, s73, 1871104
    s_mul_i32 s6, s82, 20480
    s_add_u32 s6, s6, s72
    s_mov_b64 exec, 0xffff
    buffer_load_dwordx4 v[24:27], v4, s[16:19], s6 offen sc1
    s_mov_b64 exec, -1
    s_waitcnt vmcnt(0)
L_b:
    s_cmp_lg_u32 s65, 3
    s_cbranch_scc1 L_bearly
    s_sub_u32 s66, s56, 6
    s_mov_b32 s94, 0x40000
L_g3_80:
    ds_read_b32 v12, v32 offset:4
    s_waitcnt lgkmcnt(0)
    v_readfirstlane_b32 s93, v12
    s_cmp_ge_u32 s93, s66
    s_cbranch_scc1 L_g3_ok_81
    s_sleep 2
    s_sub_u32 s94, s94, 1
    s_cmp_lg_u32 s94, 0
    s_cbranch_scc1 L_g3_80
L_g3_ok_81:
    s_mov_b32 exec_lo, 0xfff0fff
    s_mov_b32 exec_hi, 0xfff0fff
    s_mov_b64 s[68:69], exec
    v_not_b32 v163, v34
    s_mov_b64 s[84:85], exec
    v_not_b32 v167, v34
    s_mov_b64 s[86:87], exec
    v_not_b32 v171, v34
    s_mov_b64 s[96:97], exec
    v_not_b32 v175, v34
    s_mov_b64 s[98:99], exec
    v_not_b32 v179, v34
    s_mov_b64 s[6:7], exec
    v_not_b32 v183, v34
    s_mov_b64 s[66:67], exec
    v_not_b32 v187, v34
    s_mov_b64 s[10:11], exec
    v_not_b32 v191, v34
    s_mov_b32 s94, 0x8000
L_bp_poll_82:
    s_mov_b64 exec, s[68:69]
    buffer_load_dwordx4 v[160:163], v46, s[16:19], s70 offen offset:0 sc1
    s_mov_b64 exec, s[84:85]
    buffer_load_dwordx4 v[164:167], v46, s[16:19], s70 offen offset:768 sc1
    s_mov_b64 exec, s[86:87]
    buffer_load_dwordx4 v[168:171], v46, s[16:19], s70 offen offset:1536 sc1
    s_mov_b64 exec, s[96:97]
    buffer_load_dwordx4 v[172:175], v46, s[16:19], s70 offen offset:2304 sc1
    s_mov_b64 exec, s[98:99]
    buffer_load_dwordx4 v[176:179], v46, s[16:19], s71 offen offset:0 sc1
    s_mov_b64 exec, s[6:7]
    buffer_load_dwordx4 v[180:183], v46, s[16:19], s71 offen offset:768 sc1
    s_mov_b64 exec, s[66:67]
    buffer_load_dwordx4 v[184:187], v46, s[16:19], s71 offen offset:1536 sc1
    s_mov_b64 exec, s[10:11]
    buffer_load_dwordx4 v[188:191], v46, s[16:19], s71 offen offset:2304 sc1
    s_mov_b32 exec_lo, 0xfff0fff
    s_mov_b32 exec_hi, 0xfff0fff
    v_cmp_ne_u32_sdwa s[68:69], v163, v34 src0_sel:BYTE_0 src1_sel:DWORD
    v_cmp_ne_u32_sdwa s[84:85], v167, v34 src0_sel:BYTE_0 src1_sel:DWORD
    v_cmp_ne_u32_sdwa s[86:87], v171, v34 src0_sel:BYTE_0 src1_sel:DWORD
    v_cmp_ne_u32_sdwa s[96:97], v175, v34 src0_sel:BYTE_0 src1_sel:DWORD
    v_cmp_ne_u32_sdwa s[98:99], v179, v34 src0_sel:BYTE_0 src1_sel:DWORD
    v_cmp_ne_u32_sdwa s[6:7], v183, v34 src0_sel:BYTE_0 src1_sel:DWORD
    v_cmp_ne_u32_sdwa s[66:67], v187, v34 src0_sel:BYTE_0 src1_sel:DWORD
    v_cmp_ne_u32_sdwa s[10:11], v191, v34 src0_sel:BYTE_0 src1_sel:DWORD
    s_cmp_lg_u64 s[68:69], 0
    s_cselect_b64 s[68:69], exec, 0
    s_cmp_lg_u64 s[84:85], 0
    s_cselect_b64 s[84:85], exec, 0
    s_cmp_lg_u64 s[86:87], 0
    s_cselect_b64 s[86:87], exec, 0
    s_cmp_lg_u64 s[96:97], 0
    s_cselect_b64 s[96:97], exec, 0
    s_cmp_lg_u64 s[98:99], 0
    s_cselect_b64 s[98:99], exec, 0
    s_cmp_lg_u64 s[6:7], 0
    s_cselect_b64 s[6:7], exec, 0
    s_cmp_lg_u64 s[66:67], 0
    s_cselect_b64 s[66:67], exec, 0
    s_cmp_lg_u64 s[10:11], 0
    s_cselect_b64 s[10:11], exec, 0
    s_sub_u32 s94, s94, 1
    s_waitcnt vmcnt(0)
    v_xor_b32 v26, v163, v34
    v_xor_b32 v27, v167, v34
    v_bitop3_b32 v26, v26, v171, v34 bitop3:0xf6
    v_bitop3_b32 v27, v27, v175, v34 bitop3:0xf6
    v_bitop3_b32 v26, v26, v179, v34 bitop3:0xf6
    v_bitop3_b32 v27, v27, v183, v34 bitop3:0xf6
    v_bitop3_b32 v26, v26, v187, v34 bitop3:0xf6
    v_bitop3_b32 v27, v27, v191, v34 bitop3:0xf6
    v_or_b32 v26, v26, v27
    v_cmp_ne_u32_sdwa vcc, v26, v32 src0_sel:BYTE_0 src1_sel:DWORD
    s_cbranch_scc1 L_bp_ok_83
    s_cbranch_vccnz L_bp_poll_82
L_bp_ok_83:
    v_and_b32 v163, s59, v163
    v_and_b32 v167, s59, v167
    v_and_b32 v171, s59, v171
    v_and_b32 v175, s59, v175
    v_and_b32 v179, s59, v179
    v_and_b32 v183, s59, v183
    v_and_b32 v187, s59, v187
    v_and_b32 v191, s59, v191
    v_pk_add_f32 v[8:9], v[160:161], v[164:165]
    v_pk_add_f32 v[10:11], v[162:163], v[166:167]
    v_pk_add_f32 v[12:13], v[168:169], v[172:173]
    v_pk_add_f32 v[14:15], v[170:171], v[174:175]
    v_pk_add_f32 v[16:17], v[176:177], v[180:181]
    v_pk_add_f32 v[18:19], v[178:179], v[182:183]
    v_pk_add_f32 v[20:21], v[184:185], v[188:189]
    v_pk_add_f32 v[22:23], v[186:187], v[190:191]
    v_pk_add_f32 v[8:9], v[8:9], v[12:13]
    v_pk_add_f32 v[10:11], v[10:11], v[14:15]
    v_pk_add_f32 v[16:17], v[16:17], v[20:21]
    v_pk_add_f32 v[18:19], v[18:19], v[22:23]
    v_pk_add_f32 v[8:9], v[8:9], v[16:17]
    v_pk_add_f32 v[10:11], v[10:11], v[18:19]
    v_cvt_pk_bf16_f32 v24, v8, v9
    v_cvt_pk_bf16_f32 v25, v10, v11
L_bgo:
    s_mov_b64 exec, -1
    v_mov_b32_dpp v26, v24 row_shl:1 row_mask:0xf bank_mask:0xf
    v_mov_b32_dpp v27, v25 row_shl:1 row_mask:0xf bank_mask:0xf
    s_nop 1
    v_mfma_f32_16x16x32_bf16 v[192:195], v[24:27], v[64:67], 0
    v_mov_b32_dpp v28, v24 row_shl:2 row_mask:0xf bank_mask:0xf
    v_mov_b32_dpp v29, v25 row_shl:2 row_mask:0xf bank_mask:0xf
    v_mov_b32_dpp v30, v24 row_shl:3 row_mask:0xf bank_mask:0xf
    v_mov_b32_dpp v31, v25 row_shl:3 row_mask:0xf bank_mask:0xf
    v_mfma_f32_16x16x32_bf16 v[196:199], v[24:27], v[68:71], 0
    v_mfma_f32_16x16x32_bf16 v[200:203], v[24:27], v[72:75], 0
    v_mfma_f32_16x16x32_bf16 v[204:207], v[24:27], v[76:79], 0
    v_mfma_f32_16x16x32_bf16 v[192:195], v[28:31], v[80:83], v[192:195]
    v_mov_b32_dpp v36, v24 row_shl:4 row_mask:0xf bank_mask:0xf
    v_mov_b32_dpp v37, v25 row_shl:4 row_mask:0xf bank_mask:0xf
    v_mov_b32_dpp v38, v24 row_shl:5 row_mask:0xf bank_mask:0xf
    v_mov_b32_dpp v39, v25 row_shl:5 row_mask:0xf bank_mask:0xf
    v_mfma_f32_16x16x32_bf16 v[196:199], v[28:31], v[84:87], v[196:199]
    v_mfma_f32_16x16x32_bf16 v[200:203], v[28:31], v[88:91], v[200:203]
    v_mfma_f32_16x16x32_bf16 v[204:207], v[28:31], v[92:95], v[204:207]
    v_mfma_f32_16x16x32_bf16 v[192:195], v[36:39], v[96:99], v[192:195]
    v_mov_b32_dpp v28, v24 row_shl:6 row_mask:0xf bank_mask:0xf
    v_mov_b32_dpp v29, v25 row_shl:6 row_mask:0xf bank_mask:0xf
    v_mov_b32_dpp v30, v24 row_shl:7 row_mask:0xf bank_mask:0xf
    v_mov_b32_dpp v31, v25 row_shl:7 row_mask:0xf bank_mask:0xf
    v_mfma_f32_16x16x32_bf16 v[196:199], v[36:39], v[100:103], v[196:199]
    v_mfma_f32_16x16x32_bf16 v[200:203], v[36:39], v[104:107], v[200:203]
    v_mfma_f32_16x16x32_bf16 v[204:207], v[36:39], v[108:111], v[204:207]
    v_mfma_f32_16x16x32_bf16 v[192:195], v[28:31], v[112:115], v[192:195]
    v_mov_b32_dpp v36, v24 row_shl:8 row_mask:0xf bank_mask:0xf
    v_mov_b32_dpp v37, v25 row_shl:8 row_mask:0xf bank_mask:0xf
    v_mov_b32_dpp v38, v24 row_shl:9 row_mask:0xf bank_mask:0xf
    v_mov_b32_dpp v39, v25 row_shl:9 row_mask:0xf bank_mask:0xf
    v_mfma_f32_16x16x32_bf16 v[196:199], v[28:31], v[116:119], v[196:199]
    v_mfma_f32_16x16x32_bf16 v[200:203], v[28:31], v[120:123], v[200:203]
    v_mfma_f32_16x16x32_bf16 v[204:207], v[28:31], v[124:127], v[204:207]
    v_mfma_f32_16x16x32_bf16 v[192:195], v[36:39], v[128:131], v[192:195]
    v_mov_b32_dpp v28, v24 row_shl:10 row_mask:0xf bank_mask:0xf
    v_mov_b32_dpp v29, v25 row_shl:10 row_mask:0xf bank_mask:0xf
    v_mov_b32_dpp v30, v24 row_shl:11 row_mask:0xf bank_mask:0xf
    v_mov_b32_dpp v31, v25 row_shl:11 row_mask:0xf bank_mask:0xf
    v_mfma_f32_16x16x32_bf16 v[196:199], v[36:39], v[132:135], v[196:199]
    v_mfma_f32_16x16x32_bf16 v[200:203], v[36:39], v[136:139], v[200:203]
    v_mfma_f32_16x16x32_bf16 v[204:207], v[36:39], v[140:143], v[204:207]
    v_mfma_f32_16x16x32_bf16 v[192:195], v[28:31], v[144:147], v[192:195]
    v_mfma_f32_16x16x32_bf16 v[196:199], v[28:31], v[148:151], v[196:199]
    v_mfma_f32_16x16x32_bf16 v[200:203], v[28:31], v[152:155], v[200:203]
    v_mfma_f32_16x16x32_bf16 v[204:207], v[28:31], v[156:159], v[204:207]
    s_mov_b64 exec, 0xffff
    s_nop 4
    v_mov_b32 v193, v196
    v_mov_b32 v194, v200
    v_mov_b32 v195, v204
    ds_write_b128 v44, v[192:195]
    s_mov_b64 exec, 1
    ds_add_rtn_u32 v12, v45, v33
    s_mov_b64 exec, 0xffff
    ds_read_b128 v[16:19], v47 offset:0
    ds_read_b128 v[20:23], v47 offset:256
    ds_read_b128 v[24:27], v47 offset:512
    ds_read_b128 v[28:31], v47 offset:768
    s_waitcnt lgkmcnt(4)
    v_readfirstlane_b32 s6, v12
    s_cmp_lg_u32 s6, 3
    s_cbranch_scc1 L_bnext
    s_waitcnt lgkmcnt(2)
    v_pk_add_f32 v[16:17], v[16:17], v[20:21]
    v_pk_add_f32 v[18:19], v[18:19], v[22:23]
    s_waitcnt lgkmcnt(0)
    v_pk_add_f32 v[24:25], v[24:25], v[28:29]
    v_pk_add_f32 v[26:27], v[26:27], v[30:31]
    v_pk_add_f32 v[18:19], v[18:19], v[26:27]
    v_pk_add_f32 v[16:17], v[16:17], v[24:25]
    v_and_or_b32 v19, v19, s59, v35
    buffer_store_dwordx4 v[16:19], v4, s[16:19], s72 offen sc1
L_bnext:
    s_mov_b64 exec, -1
    s_waitcnt lgkmcnt(0)
    s_add_u32 s65, s65, 1
    s_cmp_eq_u32 s65, 4
    s_cbranch_scc1 L_end
    s_add_u32 s73, s73, 768
    s_add_u32 s72, s72, 20480
    v_add_u32 v44, 1024, v44
    v_add_u32 v47, 1024, v47
    v_add_u32 v45, 4, v45
    s_branch L_b
L_crole:
    s_mul_i32 s6, s82, 160
    v_add_u32 v46, s6, v43
    v_lshlrev_b32 v49, 1, v46
    v_lshlrev_b32 v46, 2, v46
    s_mul_i32 s6, 3, 1280
    buffer_load_dwordx2 v[58:59], v49, s[20:23], s6 offen
    s_mul_i32 s70, 3, 20480
    s_add_u32 s70, s70, 1294592
    s_add_u32 s71, s70, 5120
    s_add_u32 s72, s70, 10240
    s_add_u32 s73, s70, 15360
    s_mul_i32 s6, s82, 640
    v_mul_u32_u24 v5, 160, v2
    v_lshl_add_u32 v5, v1, 4, v5
    v_add_u32 v5, s6, v5
    v_lshrrev_b32 v12, 2, v1
    v_add_u32 v12, 3, v12
    v_and_b32 v12, 3, v12
    v_and_b32 v13, 3, v0
    v_lshl_add_u32 v13, v2, 2, v13
    v_lshlrev_b32 v52, 5, v12
    v_add_u32 v52, 39168, v52
    v_mul_u32_u24 v7, 1280, v12
    v_lshl_add_u32 v7, v2, 4, v7
    s_mul_i32 s6, s82, 320
    s_add_u32 s6, s6, 39808
    v_add_u32 v7, s6, v7
    v_lshlrev_b32 v42, 5, v13
    v_lshrrev_b32 v47, 2, v1
    v_lshl_add_u32 v47, v47, 9, v42
    v_lshlrev_b32 v13, 2, v13
    s_lshl_b32 s6, s91, 6
    buffer_load_dword v41, v13, s[40:43], s6 offen
    s_lshl_b32 s7, s82, 3
    v_lshl_add_u32 v44, v1, 5, s7
    v_add_u32 v48, 39296, v44
    v_lshl_add_u32 v44, v2, 9, v44
    v_add_u32 v44, 35072, v44
    v_add_u32 v6, 3, v2
    v_and_b32 v6, 3, v6
    v_mul_u32_u24 v6, 122880, v6
    v_lshl_add_u32 v6, v1, 4, v6
    v_add_u32 v50, 39808, v49
    s_lshl_b32 s7, s82, 2
    s_add_u32 s7, s7, 39168
    v_lshrrev_b32 v51, 5, v0
    v_lshl_add_u32 v51, v51, 4, s7
    v_mov_b32 v53, 0xc0135761
    s_mov_b32 s79, 0xbdd2d3e8
    s_mov_b32 s13, s91
    s_mul_i32 s6, s13, 52
    s_lshr_b32 s6, s6, 8
    s_mul_i32 s7, s6, 5
    s_sub_u32 s7, s13, s7
    s_and_b32 s6, s6, 3
    s_sub_u32 s14, 3, s6
    s_lshl_b32 s7, s7, 6
    s_mul_i32 s78, s82, 320
    s_add_u32 s78, s78, s7
    v_and_b32 v54, 7, v0
    v_lshlrev_b32 v55, 4, v54
    v_lshlrev_b32 v54, 2, v54
    v_bfe_u32 v12, v0, 4, 1
    v_lshl_add_u32 v54, v12, 1, v54
    v_lshrrev_b32 v12, 5, v0
    v_add_u32 v54, v54, v12
    v_lshlrev_b32 v54, 1, v54
    v_lshrrev_b32 v12, 3, v0
    v_mul_u32_u24 v12, 2560, v12
    v_add_u32 v55, v55, v12
    buffer_load_ushort v57, v54, s[44:47], s78 offen
    s_lshl_b32 s76, s78, 1
    s_mul_i32 s6, s14, 122880
    s_add_u32 s76, s76, s6
    s_add_u32 s76, s76, 1376512
    s_mul_i32 s6, s14, 1280
    s_add_u32 s78, s78, s6
    s_add_u32 s6, s78, 39808
    v_add_u32 v56, s6, v54
    s_mov_b32 s74, 1944832
    s_mul_i32 s12, s82, 3
    s_min_u32 s12, s12, 8
    s_mul_i32 s75, s91, 2560
    s_add_u32 s75, s75, 1376512
    s_lshl_b32 s6, s12, 8
    s_add_u32 s75, s75, s6
    s_cmp_lt_u32 s82, 2
    s_cselect_b32 s14, s75, 1956864
    buffer_load_dwordx4 v[240:243], v6, s[16:19], s75 offen offset:0 sc1
    buffer_load_dwordx4 v[244:247], v6, s[16:19], s75 offen offset:256 sc1
    buffer_load_dwordx4 v[248:251], v6, s[16:19], s14 offen offset:512 sc1
    v_mov_b32 v24, 0
    v_mov_b32 v25, 0
    s_mov_b32 exec_lo, 0x3ff03ff
    s_mov_b32 exec_hi, 0x3ff03ff
    buffer_load_dwordx4 v[24:27], v5, s[16:19], s74 offen sc1
    buffer_load_dwordx4 v[20:23], v5, s[16:19], s74 offen offset:2560 sc1
    s_mov_b64 exec, -1
    s_branch L_cw
L_c:
    s_cmp_eq_u32 s65, 2
    s_cbranch_scc1 L_c2
    s_mov_b32 s94, 0x8000
    s_mov_b32 exec_lo, 0x3ff03ff
    s_mov_b32 exec_hi, 0x3ff03ff
    v_mov_b32 v24, v20
    v_mov_b32 v25, v21
    v_mov_b32 v26, v22
    v_mov_b32 v27, v23
    s_branch L_cchk
L_coth:
    s_cmp_eq_u32 s65, 2
    s_cbranch_scc1 L_cw
L_cpoll:
    v_mov_b32 v24, 0
    v_mov_b32 v25, 0
    s_mov_b32 s94, 0x8000
    s_mov_b32 exec_lo, 0x3ff03ff
    s_mov_b32 exec_hi, 0x3ff03ff
L_ctop:
    buffer_load_dwordx4 v[24:27], v5, s[16:19], s74 offen sc1
    s_waitcnt vmcnt(0)
L_cchk:
    v_cmp_ne_u32 vcc, s58, v27
    s_cbranch_vccz L_cgo
    s_sleep 16
    s_sub_u32 s94, s94, 1
    s_cmp_lg_u32 s94, 0
    s_cbranch_scc1 L_ctop
L_cgo:
    ds_write_b64 v50, v[24:25]
    s_mov_b64 exec, -1
    v_dot2_f32_bf16 v14, v24, s62, 0
    v_dot2_f32_bf16 v15, v24, v24, 0
    v_dot2_f32_bf16 v14, v25, s62, v14
    v_dot2_f32_bf16 v15, v25, v25, v15
    s_nop 2
    v_permlane32_swap_b32 v14, v15
    v_add_f32 v14, v14, v15
    v_mov_b32 v15, v14
    s_nop 1
    v_permlane16_swap_b32 v14, v15
    v_add_f32 v14, v14, v15
    s_nop 1
    v_add_f32_dpp v14, v14, v14 row_ror:8 row_mask:0xf bank_mask:0xf
    s_nop 1
    v_add_f32_dpp v14, v14, v14 row_ror:4 row_mask:0xf bank_mask:0xf
    s_nop 1
    v_add_f32_dpp v14, v14, v14 row_ror:2 row_mask:0xf bank_mask:0xf
    s_nop 1
    v_add_f32_dpp v14, v14, v14 row_ror:1 row_mask:0xf bank_mask:0xf
    s_mov_b32 exec_lo, 0x1
    s_mov_b32 exec_hi, 0x1
    ds_write_b32 v51, v14
    s_mov_b64 exec, -1
    v_add_u32 v51, 32, v51
    v_add_u32 v50, 1280, v50
    s_add_u32 s65, s65, 1
    s_add_u32 s74, s74, 2560
    s_cmp_lt_u32 s65, 3
    s_cbranch_scc1 L_c
    s_branch L_ctail
L_cw:
    v_mul_u32_u24 v3, 24576, v2
    v_lshl_add_u32 v3, v1, 2, v3
    v_mul_u32_u24 v13, 10240, v2
    v_lshl_add_u32 v13, v1, 3, v13
    s_mul_i32 s9, s82, 491520
    s_lshl_b32 s6, s91, 6
    s_add_u32 s9, s9, s6
    s_mul_i32 s10, s91, 40960
    s_lshl_b32 s6, s12, 7
    s_add_u32 s10, s10, s6
    s_cmp_lt_u32 s82, 2
    s_cselect_b32 s11, s10, 0x1000000
    v_mov_b32 v28, s62
    v_mov_b32 v29, s62
    v_mov_b32 v30, s62
    v_mov_b32 v31, s62
    s_sub_u32 s66, s56, 2
    s_mov_b32 s94, 0x40000
L_g3_84:
    ds_read_b32 v12, v32 offset:4
    s_waitcnt lgkmcnt(0)
    v_readfirstlane_b32 s93, v12
    s_cmp_ge_u32 s93, s66
    s_cbranch_scc1 L_g3_ok_85
    s_sleep 2
    s_sub_u32 s94, s94, 1
    s_cmp_lg_u32 s94, 0
    s_cbranch_scc1 L_g3_84
L_g3_ok_85:
    buffer_load_dwordx2 v[38:39], v49, s[20:23], 0 offen offset:2560
    buffer_load_dword v160, v3, s[32:35], s9 offen offset:0
    buffer_load_dword v161, v3, s[32:35], s9 offen offset:3072
    s_add_u32 s9, s9, 6144
    buffer_load_dword v162, v3, s[32:35], s9 offen offset:0
    buffer_load_dword v163, v3, s[32:35], s9 offen offset:3072
    s_add_u32 s9, s9, 6144
    buffer_load_dword v164, v3, s[32:35], s9 offen offset:0
    buffer_load_dword v165, v3, s[32:35], s9 offen offset:3072
    s_add_u32 s9, s9, 6144
    buffer_load_dword v166, v3, s[32:35], s9 offen offset:0
    buffer_load_dword v167, v3, s[32:35], s9 offen offset:3072
    s_add_u32 s9, s9, 79872
    buffer_load_dword v168, v3, s[32:35], s9 offen offset:0
    buffer_load_dword v169, v3, s[32:35], s9 offen offset:3072
    s_add_u32 s9, s9, 6144
    buffer_load_dword v170, v3, s[32:35], s9 offen offset:0
    buffer_load_dword v171, v3, s[32:35], s9 offen offset:3072
    s_add_u32 s9, s9, 6144
    buffer_load_dword v172, v3, s[32:35], s9 offen offset:0
    buffer_load_dword v173, v3, s[32:35], s9 offen offset:3072
    s_add_u32 s9, s9, 6144
    buffer_load_dword v174, v3, s[32:35], s9 offen offset:0
    buffer_load_dword v175, v3, s[32:35], s9 offen offset:3072
    s_add_u32 s9, s9, 79872
    buffer_load_dword v176, v3, s[32:35], s9 offen offset:0
    buffer_load_dword v177, v3, s[32:35], s9 offen offset:3072
    s_add_u32 s9, s9, 6144
    buffer_load_dword v178, v3, s[32:35], s9 offen offset:0
    buffer_load_dword v179, v3, s[32:35], s9 offen offset:3072
    s_add_u32 s9, s9, 6144
    buffer_load_dword v180, v3, s[32:35], s9 offen offset:0
    buffer_load_dword v181, v3, s[32:35], s9 offen offset:3072
    s_add_u32 s9, s9, 6144
    buffer_load_dword v182, v3, s[32:35], s9 offen offset:0
    buffer_load_dword v183, v3, s[32:35], s9 offen offset:3072
    s_add_u32 s9, s9, 79872
    buffer_load_dword v184, v3, s[32:35], s9 offen offset:0
    buffer_load_dword v185, v3, s[32:35], s9 offen offset:3072
    s_add_u32 s9, s9, 6144
    buffer_load_dword v186, v3, s[32:35], s9 offen offset:0
    buffer_load_dword v187, v3, s[32:35], s9 offen offset:3072
    s_add_u32 s9, s9, 6144
    buffer_load_dword v188, v3, s[32:35], s9 offen offset:0
    buffer_load_dword v189, v3, s[32:35], s9 offen offset:3072
    s_add_u32 s9, s9, 6144
    buffer_load_dword v190, v3, s[32:35], s9 offen offset:0
    buffer_load_dword v191, v3, s[32:35], s9 offen offset:3072
    s_add_u32 s9, s9, 79872
    buffer_load_dword v192, v3, s[32:35], s9 offen offset:0
    buffer_load_dword v193, v3, s[32:35], s9 offen offset:3072
    s_add_u32 s9, s9, 6144
    buffer_load_dword v194, v3, s[32:35], s9 offen offset:0
    buffer_load_dword v195, v3, s[32:35], s9 offen offset:3072
    s_add_u32 s9, s9, 6144
    buffer_load_dword v196, v3, s[32:35], s9 offen offset:0
    buffer_load_dword v197, v3, s[32:35], s9 offen offset:3072
    s_add_u32 s9, s9, 6144
    buffer_load_dword v198, v3, s[32:35], s9 offen offset:0
    buffer_load_dword v199, v3, s[32:35], s9 offen offset:3072
    buffer_load_dwordx2 v[200:201], v13, s[36:39], s10 offen offset:0
    buffer_load_dwordx2 v[216:217], v13, s[36:39], s10 offen offset:128
    buffer_load_dwordx2 v[232:233], v13, s[36:39], s11 offen offset:256
    s_add_u32 s10, s10, 1280
    s_add_u32 s11, s11, 1280
    buffer_load_dwordx2 v[202:203], v13, s[36:39], s10 offen offset:0
    buffer_load_dwordx2 v[218:219], v13, s[36:39], s10 offen offset:128
    buffer_load_dwordx2 v[234:235], v13, s[36:39], s11 offen offset:256
    s_add_u32 s10, s10, 1280
    s_add_u32 s11, s11, 1280
    buffer_load_dwordx2 v[204:205], v13, s[36:39], s10 offen offset:0
    buffer_load_dwordx2 v[220:221], v13, s[36:39], s10 offen offset:128
    buffer_load_dwordx2 v[236:237], v13, s[36:39], s11 offen offset:256
    s_add_u32 s10, s10, 1280
    s_add_u32 s11, s11, 1280
    buffer_load_dwordx2 v[206:207], v13, s[36:39], s10 offen offset:0
    buffer_load_dwordx2 v[222:223], v13, s[36:39], s10 offen offset:128
    buffer_load_dwordx2 v[238:239], v13, s[36:39], s11 offen offset:256
    s_add_u32 s10, s10, 1280
    s_add_u32 s11, s11, 1280
    s_waitcnt vmcnt(52)
    buffer_load_dwordx2 v[208:209], v13, s[36:39], s10 offen offset:0
    buffer_load_dwordx2 v[224:225], v13, s[36:39], s10 offen offset:128
    buffer_load_dwordx2 v[240:241], v13, s[36:39], s11 offen offset:256
    s_add_u32 s10, s10, 1280
    s_add_u32 s11, s11, 1280
    buffer_load_dwordx2 v[210:211], v13, s[36:39], s10 offen offset:0
    buffer_load_dwordx2 v[226:227], v13, s[36:39], s10 offen offset:128
    buffer_load_dwordx2 v[242:243], v13, s[36:39], s11 offen offset:256
    s_add_u32 s10, s10, 1280
    s_add_u32 s11, s11, 1280
    buffer_load_dwordx2 v[212:213], v13, s[36:39], s10 offen offset:0
    buffer_load_dwordx2 v[228:229], v13, s[36:39], s10 offen offset:128
    buffer_load_dwordx2 v[244:245], v13, s[36:39], s11 offen offset:256
    s_add_u32 s10, s10, 1280
    s_add_u32 s11, s11, 1280
    s_waitcnt vmcnt(53)
    buffer_load_dwordx2 v[214:215], v13, s[36:39], s10 offen offset:0
    buffer_load_dwordx2 v[230:231], v13, s[36:39], s10 offen offset:128
    buffer_load_dwordx2 v[246:247], v13, s[36:39], s11 offen offset:256
    s_waitcnt vmcnt(56)
    v_perm_b32 v64, v161, v160, s60
    v_perm_b32 v68, v161, v160, s61
    v_perm_b32 v65, v163, v162, s60
    v_perm_b32 v69, v163, v162, s61
    v_perm_b32 v66, v165, v164, s60
    v_perm_b32 v70, v165, v164, s61
    v_perm_b32 v67, v167, v166, s60
    v_perm_b32 v71, v167, v166, s61
    s_waitcnt vmcnt(48)
    v_perm_b32 v72, v169, v168, s60
    v_perm_b32 v76, v169, v168, s61
    v_perm_b32 v73, v171, v170, s60
    v_perm_b32 v77, v171, v170, s61
    v_perm_b32 v74, v173, v172, s60
    v_perm_b32 v78, v173, v172, s61
    v_perm_b32 v75, v175, v174, s60
    v_perm_b32 v79, v175, v174, s61
    s_waitcnt vmcnt(40)
    v_perm_b32 v80, v177, v176, s60
    v_perm_b32 v84, v177, v176, s61
    v_perm_b32 v81, v179, v178, s60
    v_perm_b32 v85, v179, v178, s61
    v_perm_b32 v82, v181, v180, s60
    v_perm_b32 v86, v181, v180, s61
    v_perm_b32 v83, v183, v182, s60
    v_perm_b32 v87, v183, v182, s61
    s_waitcnt vmcnt(32)
    v_perm_b32 v88, v185, v184, s60
    v_perm_b32 v92, v185, v184, s61
    v_perm_b32 v89, v187, v186, s60
    v_perm_b32 v93, v187, v186, s61
    v_perm_b32 v90, v189, v188, s60
    v_perm_b32 v94, v189, v188, s61
    v_perm_b32 v91, v191, v190, s60
    v_perm_b32 v95, v191, v190, s61
    s_waitcnt vmcnt(24)
    v_perm_b32 v96, v193, v192, s60
    v_perm_b32 v100, v193, v192, s61
    v_perm_b32 v97, v195, v194, s60
    v_perm_b32 v101, v195, v194, s61
    v_perm_b32 v98, v197, v196, s60
    v_perm_b32 v102, v197, v196, s61
    v_perm_b32 v99, v199, v198, s60
    v_perm_b32 v103, v199, v198, s61
    v_mfma_f32_16x16x32_bf16 v[12:15], v[28:31], v[64:67], 0
    v_mfma_f32_16x16x32_bf16 v[16:19], v[28:31], v[68:71], 0
    v_mfma_f32_16x16x32_bf16 v[12:15], v[28:31], v[72:75], v[12:15]
    v_mfma_f32_16x16x32_bf16 v[16:19], v[28:31], v[76:79], v[16:19]
    v_mfma_f32_16x16x32_bf16 v[12:15], v[28:31], v[80:83], v[12:15]
    v_mfma_f32_16x16x32_bf16 v[16:19], v[28:31], v[84:87], v[16:19]
    v_mfma_f32_16x16x32_bf16 v[12:15], v[28:31], v[88:91], v[12:15]
    v_mfma_f32_16x16x32_bf16 v[16:19], v[28:31], v[92:95], v[16:19]
    v_mfma_f32_16x16x32_bf16 v[12:15], v[28:31], v[96:99], v[12:15]
    v_mfma_f32_16x16x32_bf16 v[16:19], v[28:31], v[100:103], v[16:19]
    s_mov_b64 exec, 0xffff
    s_nop 6
    ds_write2_b32 v48, v12, v16 offset0:0 offset1:1
    s_mov_b64 exec, -1
    v_lshlrev_b32 v57, 16, v57
    v_lshlrev_b32 v40, 16, v41
    v_and_b32 v41, 0xffff0000, v41
    s_mov_b32 s94, 0x8000
    s_mov_b32 exec_lo, 0x3ff03ff
    s_mov_b32 exec_hi, 0x3ff03ff
    s_branch L_cchk
L_c2:
    v_lshlrev_b32 v60, 16, v38
    v_and_b32 v61, 0xffff0000, v38
    v_lshlrev_b32 v62, 16, v39
    v_and_b32 v63, 0xffff0000, v39
    s_sub_u32 s70, s70, 20480
    s_sub_u32 s71, s71, 20480
    s_sub_u32 s72, s72, 20480
    s_sub_u32 s73, s73, 20480
    s_mov_b32 s67, 255
    s_mov_b32 s94, 0x8000
    s_mov_b32 exec_lo, 0x3ff03ff
    s_mov_b32 exec_hi, 0x3ff03ff
L_c2_poll_86:
    s_bitcmp1_b32 s67, 0
    s_cselect_b32 s68, -1, 0
    s_cbranch_scc0 L_c2_sk_88
    buffer_load_dwordx4 v[160:163], v46, s[16:19], s70 offen offset:0 sc1
L_c2_sk_88:
    s_bitcmp1_b32 s67, 1
    s_cselect_b32 s69, -1, 0
    s_cbranch_scc0 L_c2_sk_89
    buffer_load_dwordx4 v[164:167], v46, s[16:19], s70 offen offset:2560 sc1
L_c2_sk_89:
    s_bitcmp1_b32 s67, 2
    s_cselect_b32 s77, -1, 0
    s_cbranch_scc0 L_c2_sk_90
    buffer_load_dwordx4 v[168:171], v46, s[16:19], s71 offen offset:0 sc1
L_c2_sk_90:
    s_bitcmp1_b32 s67, 3
    s_cselect_b32 s83, -1, 0
    s_cbranch_scc0 L_c2_sk_91
    buffer_load_dwordx4 v[172:175], v46, s[16:19], s71 offen offset:2560 sc1
L_c2_sk_91:
    s_bitcmp1_b32 s67, 4
    s_cselect_b32 s84, -1, 0
    s_cbranch_scc0 L_c2_sk_92
    buffer_load_dwordx4 v[176:179], v46, s[16:19], s72 offen offset:0 sc1
L_c2_sk_92:
    s_bitcmp1_b32 s67, 5
    s_cselect_b32 s85, -1, 0
    s_cbranch_scc0 L_c2_sk_93
    buffer_load_dwordx4 v[180:183], v46, s[16:19], s72 offen offset:2560 sc1
L_c2_sk_93:
    s_bitcmp1_b32 s67, 6
    s_cselect_b32 s86, -1, 0
    s_cbranch_scc0 L_c2_sk_94
    buffer_load_dwordx4 v[184:187], v46, s[16:19], s73 offen offset:0 sc1
L_c2_sk_94:
    s_bitcmp1_b32 s67, 7
    s_cselect_b32 s87, -1, 0
    s_cbranch_scc0 L_c2_sk_95
    buffer_load_dwordx4 v[188:191], v46, s[16:19], s73 offen offset:2560 sc1
L_c2_sk_95:
    s_waitcnt vmcnt(0)
    v_bitop3_b32 v163, v163, v34, s68 bitop3:0x78
    v_bitop3_b32 v167, v167, v34, s69 bitop3:0x78
    v_bitop3_b32 v171, v171, v34, s77 bitop3:0x78
    v_bitop3_b32 v175, v175, v34, s83 bitop3:0x78
    v_bitop3_b32 v179, v179, v34, s84 bitop3:0x78
    v_bitop3_b32 v183, v183, v34, s85 bitop3:0x78
    v_bitop3_b32 v187, v187, v34, s86 bitop3:0x78
    v_bitop3_b32 v191, v191, v34, s87 bitop3:0x78
    v_or3_b32 v26, v163, v167, v171
    v_or3_b32 v26, v26, v175, v179
    v_or3_b32 v26, v26, v183, v187
    v_or_b32 v26, v26, v191
    v_cmp_ne_u32_sdwa vcc, v26, v32 src0_sel:BYTE_0 src1_sel:DWORD
    s_cbranch_vccz L_c2_ok_87
    s_mov_b32 s67, 0
    v_cmp_ne_u32_sdwa vcc, v163, v32 src0_sel:BYTE_0 src1_sel:DWORD
    s_cmp_lg_u64 vcc, 0
    s_cselect_b32 s6, 1, 0
    s_or_b32 s67, s67, s6
    v_cmp_ne_u32_sdwa vcc, v167, v32 src0_sel:BYTE_0 src1_sel:DWORD
    s_cmp_lg_u64 vcc, 0
    s_cselect_b32 s6, 2, 0
    s_or_b32 s67, s67, s6
    v_cmp_ne_u32_sdwa vcc, v171, v32 src0_sel:BYTE_0 src1_sel:DWORD
    s_cmp_lg_u64 vcc, 0
    s_cselect_b32 s6, 4, 0
    s_or_b32 s67, s67, s6
    v_cmp_ne_u32_sdwa vcc, v175, v32 src0_sel:BYTE_0 src1_sel:DWORD
    s_cmp_lg_u64 vcc, 0
    s_cselect_b32 s6, 8, 0
    s_or_b32 s67, s67, s6
    v_cmp_ne_u32_sdwa vcc, v179, v32 src0_sel:BYTE_0 src1_sel:DWORD
    s_cmp_lg_u64 vcc, 0
    s_cselect_b32 s6, 16, 0
    s_or_b32 s67, s67, s6
    v_cmp_ne_u32_sdwa vcc, v183, v32 src0_sel:BYTE_0 src1_sel:DWORD
    s_cmp_lg_u64 vcc, 0
    s_cselect_b32 s6, 32, 0
    s_or_b32 s67, s67, s6
    v_cmp_ne_u32_sdwa vcc, v187, v32 src0_sel:BYTE_0 src1_sel:DWORD
    s_cmp_lg_u64 vcc, 0
    s_cselect_b32 s6, 64, 0
    s_or_b32 s67, s67, s6
    v_cmp_ne_u32_sdwa vcc, v191, v32 src0_sel:BYTE_0 src1_sel:DWORD
    s_cmp_lg_u64 vcc, 0
    s_cselect_b32 s6, 128, 0
    s_or_b32 s67, s67, s6
    s_sleep 4
    s_sub_u32 s94, s94, 1
    s_cmp_lg_u32 s94, 0
    s_cbranch_scc1 L_c2_poll_86
L_c2_ok_87:
    v_pk_add_f32 v[8:9], v[160:161], v[164:165]
    v_pk_add_f32 v[10:11], v[162:163], v[166:167]
    v_pk_add_f32 v[12:13], v[168:169], v[172:173]
    v_pk_add_f32 v[14:15], v[170:171], v[174:175]
    v_pk_add_f32 v[16:17], v[176:177], v[180:181]
    v_pk_add_f32 v[18:19], v[178:179], v[182:183]
    v_pk_add_f32 v[20:21], v[184:185], v[188:189]
    v_pk_add_f32 v[22:23], v[186:187], v[190:191]
    v_pk_add_f32 v[8:9], v[8:9], v[12:13]
    v_pk_add_f32 v[10:11], v[10:11], v[14:15]
    v_pk_add_f32 v[16:17], v[16:17], v[20:21]
    v_pk_add_f32 v[18:19], v[18:19], v[22:23]
    v_pk_add_f32 v[8:9], v[8:9], v[16:17]
    v_pk_add_f32 v[10:11], v[10:11], v[18:19]
    v_cvt_pk_bf16_f32 v12, v8, v9
    v_cvt_pk_bf16_f32 v13, v10, v11
    v_lshlrev_b32 v8, 16, v12
    v_and_b32 v9, 0xffff0000, v12
    v_lshlrev_b32 v10, 16, v13
    v_and_b32 v11, 0xffff0000, v13
    v_pk_add_f32 v[8:9], v[8:9], v[60:61]
    v_pk_add_f32 v[10:11], v[10:11], v[62:63]
    v_cvt_pk_bf16_f32 v24, v8, v9
    v_cvt_pk_bf16_f32 v25, v10, v11
    s_add_u32 s70, s70, 20480
    s_add_u32 s71, s71, 20480
    s_add_u32 s72, s72, 20480
    s_add_u32 s73, s73, 20480
    v_lshlrev_b32 v60, 16, v58
    v_and_b32 v61, 0xffff0000, v58
    v_lshlrev_b32 v62, 16, v59
    v_and_b32 v63, 0xffff0000, v59
    s_branch L_cgo
L_ctail:
    v_perm_b32 v136, v234, v232, s60
    v_perm_b32 v140, v234, v232, s61
    v_perm_b32 v137, v238, v236, s60
    v_perm_b32 v141, v238, v236, s61
    v_perm_b32 v138, v242, v240, s60
    v_perm_b32 v142, v242, v240, s61
    v_perm_b32 v139, v246, v244, s60
    v_perm_b32 v143, v246, v244, s61
    v_perm_b32 v144, v235, v233, s60
    v_perm_b32 v148, v235, v233, s61
    v_perm_b32 v145, v239, v237, s60
    v_perm_b32 v149, v239, v237, s61
    v_perm_b32 v146, v243, v241, s60
    v_perm_b32 v150, v243, v241, s61
    v_perm_b32 v147, v247, v245, s60
    v_perm_b32 v151, v247, v245, s61
    ds_read_b128 v[232:235], v7 offset:0
    ds_read_b128 v[236:239], v7 offset:64
    ds_read_b128 v[240:243], v7 offset:128
    ds_read_b128 v[244:247], v7 offset:192
    ds_read_b128 v[248:251], v7 offset:256
    v_perm_b32 v104, v202, v200, s60
    v_perm_b32 v108, v202, v200, s61
    v_perm_b32 v105, v206, v204, s60
    v_perm_b32 v109, v206, v204, s61
    v_perm_b32 v106, v210, v208, s60
    v_perm_b32 v110, v210, v208, s61
    v_perm_b32 v107, v214, v212, s60
    v_perm_b32 v111, v214, v212, s61
    v_perm_b32 v112, v203, v201, s60
    v_perm_b32 v116, v203, v201, s61
    v_perm_b32 v113, v207, v205, s60
    v_perm_b32 v117, v207, v205, s61
    v_perm_b32 v114, v211, v209, s60
    v_perm_b32 v118, v211, v209, s61
    v_perm_b32 v115, v215, v213, s60
    v_perm_b32 v119, v215, v213, s61
    v_perm_b32 v120, v218, v216, s60
    v_perm_b32 v124, v218, v216, s61
    v_perm_b32 v121, v222, v220, s60
    v_perm_b32 v125, v222, v220, s61
    v_perm_b32 v122, v226, v224, s60
    v_perm_b32 v126, v226, v224, s61
    v_perm_b32 v123, v230, v228, s60
    v_perm_b32 v127, v230, v228, s61
    v_perm_b32 v128, v219, v217, s60
    v_perm_b32 v132, v219, v217, s61
    v_perm_b32 v129, v223, v221, s60
    v_perm_b32 v133, v223, v221, s61
    v_perm_b32 v130, v227, v225, s60
    v_perm_b32 v134, v227, v225, s61
    v_perm_b32 v131, v231, v229, s60
    v_perm_b32 v135, v231, v229, s61
    v_mov_b32 v24, 0
    v_mov_b32 v25, 0
    s_sub_u32 s66, s56, 0
    s_mov_b32 s94, 0x40000
L_g3_96:
    ds_read_b32 v12, v32 offset:4
    s_waitcnt lgkmcnt(0)
    v_readfirstlane_b32 s93, v12
    s_cmp_ge_u32 s93, s66
    s_cbranch_scc1 L_g3_ok_97
    s_sleep 2
    s_sub_u32 s94, s94, 1
    s_cmp_lg_u32 s94, 0
    s_cbranch_scc1 L_g3_96
L_g3_ok_97:
    s_mov_b32 exec_lo, 0x3ff03ff
    s_mov_b32 exec_hi, 0x3ff03ff
    s_mov_b64 s[68:69], exec
    v_not_b32 v163, v34
    s_mov_b64 s[84:85], exec
    v_not_b32 v167, v34
    s_mov_b64 s[86:87], exec
    v_not_b32 v171, v34
    s_mov_b64 s[96:97], exec
    v_not_b32 v175, v34
    s_mov_b64 s[98:99], exec
    v_not_b32 v179, v34
    s_mov_b64 s[6:7], exec
    v_not_b32 v183, v34
    s_mov_b64 s[66:67], exec
    v_not_b32 v187, v34
    s_mov_b64 s[10:11], exec
    v_not_b32 v191, v34
    s_mov_b32 s94, 0x8000
L_cy_poll_98:
    s_mov_b64 exec, s[68:69]
    buffer_load_dwordx4 v[160:163], v46, s[16:19], s70 offen offset:0 sc1
    s_mov_b64 exec, s[84:85]
    buffer_load_dwordx4 v[164:167], v46, s[16:19], s70 offen offset:2560 sc1
    s_mov_b64 exec, s[86:87]
    buffer_load_dwordx4 v[168:171], v46, s[16:19], s71 offen offset:0 sc1
    s_mov_b64 exec, s[96:97]
    buffer_load_dwordx4 v[172:175], v46, s[16:19], s71 offen offset:2560 sc1
    s_mov_b64 exec, s[98:99]
    buffer_load_dwordx4 v[176:179], v46, s[16:19], s72 offen offset:0 sc1
    s_mov_b64 exec, s[6:7]
    buffer_load_dwordx4 v[180:183], v46, s[16:19], s72 offen offset:2560 sc1
    s_mov_b64 exec, s[66:67]
    buffer_load_dwordx4 v[184:187], v46, s[16:19], s73 offen offset:0 sc1
    s_mov_b64 exec, s[10:11]
    buffer_load_dwordx4 v[188:191], v46, s[16:19], s73 offen offset:2560 sc1
    s_mov_b32 exec_lo, 0x3ff03ff
    s_mov_b32 exec_hi, 0x3ff03ff
    v_cmp_ne_u32_sdwa s[68:69], v163, v34 src0_sel:BYTE_0 src1_sel:DWORD
    v_cmp_ne_u32_sdwa s[84:85], v167, v34 src0_sel:BYTE_0 src1_sel:DWORD
    v_cmp_ne_u32_sdwa s[86:87], v171, v34 src0_sel:BYTE_0 src1_sel:DWORD
    v_cmp_ne_u32_sdwa s[96:97], v175, v34 src0_sel:BYTE_0 src1_sel:DWORD
    v_cmp_ne_u32_sdwa s[98:99], v179, v34 src0_sel:BYTE_0 src1_sel:DWORD
    v_cmp_ne_u32_sdwa s[6:7], v183, v34 src0_sel:BYTE_0 src1_sel:DWORD
    v_cmp_ne_u32_sdwa s[66:67], v187, v34 src0_sel:BYTE_0 src1_sel:DWORD
    v_cmp_ne_u32_sdwa s[10:11], v191, v34 src0_sel:BYTE_0 src1_sel:DWORD
    s_cmp_lg_u64 s[68:69], 0
    s_cselect_b64 s[68:69], exec, 0
    s_cmp_lg_u64 s[84:85], 0
    s_cselect_b64 s[84:85], exec, 0
    s_cmp_lg_u64 s[86:87], 0
    s_cselect_b64 s[86:87], exec, 0
    s_cmp_lg_u64 s[96:97], 0
    s_cselect_b64 s[96:97], exec, 0
    s_cmp_lg_u64 s[98:99], 0
    s_cselect_b64 s[98:99], exec, 0
    s_cmp_lg_u64 s[6:7], 0
    s_cselect_b64 s[6:7], exec, 0
    s_cmp_lg_u64 s[66:67], 0
    s_cselect_b64 s[66:67], exec, 0
    s_cmp_lg_u64 s[10:11], 0
    s_cselect_b64 s[10:11], exec, 0
    s_sub_u32 s94, s94, 1
    s_waitcnt vmcnt(0)
    v_xor_b32 v26, v163, v34
    v_xor_b32 v27, v167, v34
    v_bitop3_b32 v26, v26, v171, v34 bitop3:0xf6
    v_bitop3_b32 v27, v27, v175, v34 bitop3:0xf6
    v_bitop3_b32 v26, v26, v179, v34 bitop3:0xf6
    v_bitop3_b32 v27, v27, v183, v34 bitop3:0xf6
    v_bitop3_b32 v26, v26, v187, v34 bitop3:0xf6
    v_bitop3_b32 v27, v27, v191, v34 bitop3:0xf6
    v_or_b32 v26, v26, v27
    v_cmp_ne_u32_sdwa vcc, v26, v32 src0_sel:BYTE_0 src1_sel:DWORD
    s_cbranch_scc1 L_cy_ok_99
    s_cbranch_vccnz L_cy_poll_98
L_cy_ok_99:
    v_and_b32 v163, s59, v163
    v_and_b32 v167, s59, v167
    v_and_b32 v171, s59, v171
    v_and_b32 v175, s59, v175
    v_and_b32 v179, s59, v179
    v_and_b32 v183, s59, v183
    v_and_b32 v187, s59, v187
    v_and_b32 v191, s59, v191
    v_pk_add_f32 v[8:9], v[160:161], v[164:165]
    v_pk_add_f32 v[10:11], v[162:163], v[166:167]
    v_pk_add_f32 v[12:13], v[168:169], v[172:173]
    v_pk_add_f32 v[14:15], v[170:171], v[174:175]
    v_pk_add_f32 v[16:17], v[176:177], v[180:181]
    v_pk_add_f32 v[18:19], v[178:179], v[182:183]
    v_pk_add_f32 v[20:21], v[184:185], v[188:189]
    v_pk_add_f32 v[22:23], v[186:187], v[190:191]
    v_pk_add_f32 v[8:9], v[8:9], v[12:13]
    v_pk_add_f32 v[10:11], v[10:11], v[14:15]
    v_pk_add_f32 v[16:17], v[16:17], v[20:21]
    v_pk_add_f32 v[18:19], v[18:19], v[22:23]
    v_pk_add_f32 v[8:9], v[8:9], v[16:17]
    v_pk_add_f32 v[10:11], v[10:11], v[18:19]
    v_cvt_pk_bf16_f32 v12, v8, v9
    v_cvt_pk_bf16_f32 v13, v10, v11
    v_lshlrev_b32 v8, 16, v12
    v_and_b32 v9, 0xffff0000, v12
    v_lshlrev_b32 v10, 16, v13
    v_and_b32 v11, 0xffff0000, v13
    v_pk_add_f32 v[8:9], v[8:9], v[60:61]
    v_pk_add_f32 v[10:11], v[10:11], v[62:63]
    v_cvt_pk_bf16_f32 v24, v8, v9
    v_cvt_pk_bf16_f32 v25, v10, v11
    ds_write_b64 v50, v[24:25]
    s_mov_b64 exec, -1
L_cmm:
    v_mov_b32_dpp v232, v24 quad_perm:[0,1,2,3] row_mask:0xf bank_mask:0x1
    v_mov_b32_dpp v233, v25 quad_perm:[0,1,2,3] row_mask:0xf bank_mask:0x1
    v_mov_b32_dpp v234, v24 row_shl:1 row_mask:0xf bank_mask:0x1
    v_mov_b32_dpp v235, v25 row_shl:1 row_mask:0xf bank_mask:0x1
    s_nop 1
    v_mfma_f32_16x16x32_bf16 v[192:195], v[232:235], v[64:67], 0
    v_mov_b32_dpp v236, v24 row_shl:2 row_mask:0xf bank_mask:0x1
    v_mov_b32_dpp v237, v25 row_shl:2 row_mask:0xf bank_mask:0x1
    v_mov_b32_dpp v238, v24 row_shl:3 row_mask:0xf bank_mask:0x1
    v_mov_b32_dpp v239, v25 row_shl:3 row_mask:0xf bank_mask:0x1
    v_dot2_f32_bf16 v14, v24, s62, 0
    v_dot2_f32_bf16 v15, v24, v24, 0
    v_mfma_f32_16x16x32_bf16 v[196:199], v[232:235], v[68:71], 0
    v_dot2_f32_bf16 v14, v25, s62, v14
    v_dot2_f32_bf16 v15, v25, v25, v15
    v_mfma_f32_16x16x32_bf16 v[192:195], v[236:239], v[72:75], v[192:195]
    v_mov_b32_dpp v240, v24 row_shl:4 row_mask:0xf bank_mask:0x1
    v_mov_b32_dpp v241, v25 row_shl:4 row_mask:0xf bank_mask:0x1
    v_mov_b32_dpp v242, v24 row_shl:5 row_mask:0xf bank_mask:0x1
    v_mov_b32_dpp v243, v25 row_shl:5 row_mask:0xf bank_mask:0x1
    v_mfma_f32_16x16x32_bf16 v[196:199], v[236:239], v[76:79], v[196:199]
    v_permlane32_swap_b32 v14, v15
    v_add_f32 v14, v14, v15
    v_mov_b32 v15, v14
    v_mfma_f32_16x16x32_bf16 v[192:195], v[240:243], v[80:83], v[192:195]
    v_mov_b32_dpp v244, v24 row_shl:6 row_mask:0xf bank_mask:0x1
    v_mov_b32_dpp v245, v25 row_shl:6 row_mask:0xf bank_mask:0x1
    v_mov_b32_dpp v246, v24 row_shl:7 row_mask:0xf bank_mask:0x1
    v_mov_b32_dpp v247, v25 row_shl:7 row_mask:0xf bank_mask:0x1
    v_permlane16_swap_b32 v14, v15
    v_add_f32 v14, v14, v15
    v_mfma_f32_16x16x32_bf16 v[196:199], v[240:243], v[84:87], v[196:199]
    s_nop 0
    v_add_f32_dpp v14, v14, v14 row_ror:8 row_mask:0xf bank_mask:0xf
    v_mfma_f32_16x16x32_bf16 v[192:195], v[244:247], v[88:91], v[192:195]
    v_mov_b32_dpp v248, v24 row_shl:8 row_mask:0xf bank_mask:0x1
    v_mov_b32_dpp v249, v25 row_shl:8 row_mask:0xf bank_mask:0x1
    v_mov_b32_dpp v250, v24 row_shl:9 row_mask:0xf bank_mask:0x1
    v_mov_b32_dpp v251, v25 row_shl:9 row_mask:0xf bank_mask:0x1
    v_add_f32_dpp v14, v14, v14 row_ror:4 row_mask:0xf bank_mask:0xf
    v_mfma_f32_16x16x32_bf16 v[196:199], v[244:247], v[92:95], v[196:199]
    s_nop 0
    v_add_f32_dpp v14, v14, v14 row_ror:2 row_mask:0xf bank_mask:0xf
    v_mfma_f32_16x16x32_bf16 v[192:195], v[248:251], v[96:99], v[192:195]
    s_nop 0
    v_add_f32_dpp v14, v14, v14 row_ror:1 row_mask:0xf bank_mask:0xf
    v_mfma_f32_16x16x32_bf16 v[196:199], v[248:251], v[100:103], v[196:199]
    s_mov_b32 exec_lo, 0x1
    s_mov_b32 exec_hi, 0x1
    ds_write_b32 v51, v14
    s_mov_b64 exec, -1
    s_nop 3
    ds_write2_b32 v44, v192, v196 offset0:0 offset1:1
    s_mov_b64 exec, 1
    ds_add_u32 v45, v33
    s_mov_b64 exec, -1
    s_mov_b32 s94, 0x100000
L_cjoin:
    ds_read_b32 v28, v45
    ds_read_b128 v[20:23], v52
    ds_read_b128 v[36:39], v52 offset:16
    ds_read_b128 v[8:11], v47 offset:35072
    ds_read_b128 v[12:15], v47 offset:35088
    ds_read_b128 v[200:203], v42 offset:39296
    ds_read_b128 v[204:207], v42 offset:39312
    s_waitcnt lgkmcnt(6)
    v_readfirstlane_b32 s6, v28
    s_cmp_ge_u32 s6, 4
    s_cbranch_scc1 L_cjoined
    s_waitcnt lgkmcnt(0)
    s_sub_u32 s94, s94, 1
    s_cmp_lg_u32 s94, 0
    s_cbranch_scc1 L_cjoin
L_cjoined:
    s_waitcnt lgkmcnt(4)
    v_pk_add_f32 v[20:21], v[20:21], v[22:23]
    v_pk_add_f32 v[36:37], v[36:37], v[38:39]
    v_add_f32 v20, v20, v21
    v_add_f32 v21, v36, v37
    v_mul_f32 v20, 0x3acccccd, v20
    v_mul_f32 v21, 0x3acccccd, v21
    v_fma_f32 v21, -v20, v20, v21
    v_max_f32 v21, 0, v21
    v_cvt_pk_bf16_f32 v22, v20, v21
    v_lshlrev_b32 v20, 16, v22
    v_and_b32 v21, 0xffff0000, v22
    v_add_f32 v21, 0x3727c5ac, v21
    v_cvt_pk_bf16_f32 v21, v21, v21
    v_and_b32 v21, 0xffff0000, v21
    v_sqrt_f32 v21, v21
    s_nop 0
    v_cvt_pk_bf16_f32 v21, v21, v21
    v_and_b32 v21, 0xffff0000, v21
    v_rcp_f32 v21, v21
    s_waitcnt lgkmcnt(0)
    v_pk_add_f32 v[8:9], v[8:9], v[12:13]
    v_pk_add_f32 v[10:11], v[10:11], v[14:15]
    v_pk_add_f32 v[200:201], v[200:201], v[202:203]
    v_pk_add_f32 v[204:205], v[204:205], v[206:207]
    v_pk_add_f32 v[8:9], v[8:9], v[10:11]
    v_pk_add_f32 v[200:201], v[200:201], v[204:205]
    v_fma_f32 v8, -v20, v200, v8
    v_fma_f32 v9, -v20, v201, v9
    v_mul_f32 v8, v8, v21
    v_mul_f32 v9, v9, v21
    v_cvt_pk_bf16_f32 v10, v8, v9
    v_lshlrev_b32 v8, 16, v10
    v_and_b32 v9, 0xffff0000, v10
    v_pk_add_f32 v[8:9], v[8:9], v[40:41]
    v_cvt_pk_bf16_f32 v10, v8, v9
    v_lshlrev_b32 v8, 16, v10
    v_and_b32 v9, 0xffff0000, v10
    v_pk_mul_f32 v[10:11], v[8:9], v[8:9]
    v_fma_f32 v10, v10, s79, v53
    v_fma_f32 v11, v11, s79, v53
    v_pk_mul_f32 v[10:11], v[10:11], v[8:9]
    v_exp_f32 v10, v10
    v_exp_f32 v11, v11
    v_add_f32 v10, 1.0, v10
    v_add_f32 v11, 1.0, v11
    v_rcp_f32 v10, v10
    v_rcp_f32 v11, v11
    s_nop 0
    v_pk_mul_f32 v[8:9], v[8:9], v[10:11]
    v_cvt_pk_bf16_f32 v24, v8, v9
    s_nop 1
    v_mov_b32_dpp v25, v24 row_shl:1 row_mask:0xf bank_mask:0xf
    v_mov_b32_dpp v26, v24 row_shl:2 row_mask:0xf bank_mask:0xf
    v_mov_b32_dpp v27, v24 row_shl:3 row_mask:0xf bank_mask:0xf
    s_nop 1
    v_mfma_f32_16x16x32_bf16 v[192:195], v[24:27], v[104:107], 0
    v_mfma_f32_16x16x32_bf16 v[196:199], v[24:27], v[108:111], 0
    v_mfma_f32_16x16x32_bf16 v[200:203], v[24:27], v[112:115], 0
    v_mfma_f32_16x16x32_bf16 v[204:207], v[24:27], v[116:119], 0
    v_mfma_f32_16x16x32_bf16 v[208:211], v[24:27], v[120:123], 0
    v_mfma_f32_16x16x32_bf16 v[212:215], v[24:27], v[124:127], 0
    v_mfma_f32_16x16x32_bf16 v[216:219], v[24:27], v[128:131], 0
    v_mfma_f32_16x16x32_bf16 v[220:223], v[24:27], v[132:135], 0
    v_mfma_f32_16x16x32_bf16 v[224:227], v[24:27], v[136:139], 0
    v_mfma_f32_16x16x32_bf16 v[228:231], v[24:27], v[140:143], 0
    v_mfma_f32_16x16x32_bf16 v[232:235], v[24:27], v[144:147], 0
    v_mfma_f32_16x16x32_bf16 v[236:239], v[24:27], v[148:151], 0
    v_mov_b32 v193, v196
    v_mov_b32 v194, v200
    v_and_or_b32 v195, v204, s59, v35
    buffer_store_dwordx4 v[192:195], v6, s[16:19], s75 offen offset:0 sc1
    v_mov_b32 v209, v212
    v_mov_b32 v210, v216
    v_and_or_b32 v211, v220, s59, v35
    buffer_store_dwordx4 v[208:211], v6, s[16:19], s75 offen offset:256 sc1
    v_mov_b32 v225, v228
    v_mov_b32 v226, v232
    v_and_or_b32 v227, v236, s59, v35
    buffer_store_dwordx4 v[224:227], v6, s[16:19], s14 offen offset:512 sc1
    s_cmp_ge_u32 s13, 20
    s_cbranch_scc1 L_end
    ds_read_u16 v29, v56
    s_add_u32 s70, s76, 20480
    s_add_u32 s71, s76, 40960
    s_add_u32 s72, s76, 61440
    s_add_u32 s73, s76, 81920
    s_add_u32 s74, s76, 102400
    s_mov_b32 s94, 0x8000
    s_sleep 8
L_d:
    buffer_load_dwordx4 v[160:163], v55, s[16:19], s76 offen sc1
    buffer_load_dwordx4 v[164:167], v55, s[16:19], s70 offen sc1
    buffer_load_dwordx4 v[168:171], v55, s[16:19], s71 offen sc1
    buffer_load_dwordx4 v[172:175], v55, s[16:19], s72 offen sc1
    buffer_load_dwordx4 v[176:179], v55, s[16:19], s73 offen sc1
    buffer_load_dwordx4 v[180:183], v55, s[16:19], s74 offen sc1
    s_waitcnt vmcnt(4)
    v_xor_b32 v163, v163, v35
    v_xor_b32 v167, v167, v35
    v_or3_b32 v26, v163, v167, v32
    v_pk_add_f32 v[8:9], v[160:161], v[164:165]
    v_pk_add_f32 v[10:11], v[162:163], v[166:167]
    s_waitcnt vmcnt(2)
    v_xor_b32 v171, v171, v35
    v_xor_b32 v175, v175, v35
    v_or3_b32 v26, v171, v175, v26
    v_pk_add_f32 v[12:13], v[168:169], v[172:173]
    v_pk_add_f32 v[14:15], v[170:171], v[174:175]
    v_pk_add_f32 v[8:9], v[8:9], v[12:13]
    v_pk_add_f32 v[10:11], v[10:11], v[14:15]
    s_waitcnt vmcnt(0)
    v_xor_b32 v179, v179, v35
    v_xor_b32 v183, v183, v35
    v_or3_b32 v26, v179, v183, v26
    v_cmp_ne_u32_sdwa vcc, v26, v32 src0_sel:BYTE_0 src1_sel:DWORD
    v_pk_add_f32 v[16:17], v[176:177], v[180:181]
    v_pk_add_f32 v[18:19], v[178:179], v[182:183]
    v_pk_add_f32 v[8:9], v[8:9], v[16:17]
    v_pk_add_f32 v[10:11], v[10:11], v[18:19]
    s_cbranch_vccz L_dok
    s_sub_u32 s94, s94, 1
    s_cmp_lg_u32 s94, 0
    s_cbranch_scc1 L_d
L_dok:
    v_permlane32_swap_b32 v8, v9
    v_permlane32_swap_b32 v10, v11
    v_add_f32 v8, v8, v9
    v_add_f32 v10, v10, v11
    s_nop 1
    v_permlane16_swap_b32 v8, v10
    v_add_f32 v8, v8, v10
    s_nop 1
    v_add_f32_dpp v8, v8, v8 row_ror:8 row_mask:0xf bank_mask:0xf
    s_waitcnt lgkmcnt(0)
    v_lshlrev_b32 v29, 16, v29
    v_cvt_pk_bf16_f32 v8, v8, v8
    v_and_b32 v8, 0xffff0000, v8
    v_add_f32 v8, v8, v57
    v_cvt_pk_bf16_f32 v8, v8, v8
    v_and_b32 v8, 0xffff0000, v8
    v_add_f32 v8, v8, v29
    v_cvt_pk_bf16_f32 v8, v8, v8
    s_mov_b32 exec_lo, 0xff00ff
    s_mov_b32 exec_hi, 0xff00ff
    buffer_store_short v8, v54, s[48:51], s78 offen
    s_or_b32 s6, s13, s82
    s_cmp_eq_u32 s6, 0
    s_cselect_b32 s6, 0, 1956864
    s_add_u32 s7, s57, 1
    v_mov_b32 v9, s7
    s_mov_b64 exec, 1
    buffer_store_dword v9, v32, s[16:19], s6 offen
L_end:
    s_endpgm
L_prep:
    s_mov_b32 exec_hi, 0xffff
    buffer_load_dwordx4 v[144:147], v34, s[16:19], s86 offen sc1 nt
    s_mov_b32 exec_hi, -1
    s_branch L_prepd
L_dev_7:
    buffer_store_dwordx4 v[160:163], v34, s[16:19], s86 offen sc1
    s_branch L_devb_8
L_dev_24:
    buffer_store_dwordx4 v[12:15], v32, s[16:19], s10 offen sc1
    s_branch L_devb_25
L_dev_33:
    buffer_store_dwordx4 v[160:163], v4, s[16:19], s7 offen sc1
    s_branch L_devb_34
L_dev_35:
    buffer_store_dword v12, v32, s[16:19], s6 offen sc1
    s_branch L_devb_36
L_dev_53:
    buffer_store_dwordx4 v[24:27], v5, s[16:19], s72 offen sc1
    s_branch L_devb_54
L_dev_74:
    buffer_store_dwordx4 v[160:163], v4, s[16:19], s7 offen sc1
    s_branch L_devb_75
L_dev_76:
    buffer_store_dword v12, v32, s[16:19], s6 offen sc1
    s_branch L_devb_77
    s_endpgm
.section .rodata,"a"
.p2align 6
.amdhsa_kernel sequential_preLN__mha_block_cached__dense_activation_gelu__decode_kernel
  .amdhsa_next_free_vgpr 256
  .amdhsa_next_free_sgpr 102
  .amdhsa_accum_offset 256
  .amdhsa_group_segment_fixed_size 0
  .amdhsa_kernarg_size 104
  .amdhsa_user_sgpr_count 2
  .amdhsa_user_sgpr_kernarg_segment_ptr 1
  .amdhsa_system_sgpr_workgroup_id_x 1
.end_amdhsa_kernel
```
